```python
import torch

def _softmax(x, axis=-1):
    return torch.softmax(x, dim=axis)
def _gelu(x):
    return torch.nn.functional.gelu(x, approximate="tanh")
def _silu(x):
    return torch.nn.functional.silu(x)
def _sigmoid(x):
    return torch.sigmoid(x)
def _layernorm(x, axis=-1, eps=1e-5):
    m = x.mean(dim=axis, keepdim=True)
    v = x.var(dim=axis, keepdim=True, unbiased=False)
    return (x - m) / torch.sqrt(v + eps)
def _scatter_add(tgt, idx, src, axis=0):
    return tgt.clone().index_add_(axis, idx, src)
def _segment_sum(src, seg, n):
    out = torch.zeros((n,) + src.shape[1:], dtype=src.dtype)
    return out.index_add_(0, seg, src)
def _pad(x, pw):
    flat = tuple(v for pair in reversed(pw) for v in pair)
    return torch.nn.functional.pad(x, flat)

kernel_name = 'standalone__gqa_softmax__near_ridge'

def setup_inputs():

    _w = (lambda a: (lambda t: t.to(torch.bfloat16) if t.is_floating_point() else t)(torch.as_tensor(a)))
    B, Hq, Hkv, Sq, Sk, D = 32, 32, 32, 192, 512, 128
    return {
        "q": _w((lambda *s: torch.randn(*s, dtype=torch.bfloat16) * 0.8)(B, Hq, Sq, D)),
        "k": _w((lambda *s: torch.randn(*s, dtype=torch.bfloat16) * 0.8)(B, Hkv, Sk, D)),
        "v": _w((lambda *s: torch.randn(*s, dtype=torch.bfloat16) * 0.05)(B, Hkv, Sk, D)),
    }

def reference(q, k, v):
    B, Hq, Sq, D = q.shape
    Hkv = k.shape[1]
    rep = Hq // Hkv
    k = (lambda x, n, axis: torch.repeat_interleave(x, n, dim=axis))(k, rep, axis=1)
    v = (lambda x, n, axis: torch.repeat_interleave(x, n, dim=axis))(v, rep, axis=1)
    scale = D ** -0.5
    scores = torch.einsum("bhqd,bhkd->bhqk", q, k) * scale
    p = _softmax(scores, axis=-1)
    return torch.einsum("bhqk,bhkd->bhqd", p, v)
```

```asm
; @launch grid=(512,1,1) block=(256,1,1) lds=81920
.amdgcn_target "amdgcn-amd-amdhsa--gfx950"
.text
.globl standalone__gqa_softmax__near_ridge_kernel
.p2align 8
.type standalone__gqa_softmax__near_ridge_kernel,@function
standalone__gqa_softmax__near_ridge_kernel:
    s_cmp_ge_u32 s2, 512
    s_cbranch_scc1 L_end
    s_load_dwordx4 s[36:39], s[0:1], 0
    s_load_dwordx4 s[40:43], s[0:1], 16
    v_and_b32 v9, 63, v0
    v_lshrrev_b32 v1, 6, v0
    v_and_b32 v2, 15, v9
    v_readfirstlane_b32 s20, v1
    v_lshrrev_b32 v3, 4, v9
    v_lshrrev_b32 v4, 2, v2
    v_and_b32 v5, 3, v2
    s_lshl_b32 s21, s20, 12
    s_lshl_b32 s33, s20, 2
    v_lshlrev_b32 v6, 8, v3
    v_add_u32 v6, s21, v6
    v_add_u32 v7, s33, v3
    v_xor_b32 v7, v7, v2
    v_lshl_add_u32 v236, v7, 4, v6
    s_mul_i32 s33, s2, 2
    s_lshl_b32 s27, s33, 17
    s_mul_i32 s28, s33, 49152
    s_mov_b32 m0, s21
    s_add_u32 s33, s28, 16384
    s_add_u32 s34, s28, 32768
    s_mov_b32 s6, 50331648
    s_mov_b32 s7, 0x20000
    s_waitcnt lgkmcnt(0)
    s_mov_b32 s4, s36
    s_and_b32 s5, s37, 0xffff
    buffer_load_dwordx4 v236, s[4:7], s28 offen nt lds
    buffer_load_dwordx4 v236, s[4:7], s28 offen offset:1024 nt lds
    buffer_load_dwordx4 v236, s[4:7], s28 offen offset:2048 nt lds
    buffer_load_dwordx4 v236, s[4:7], s28 offen offset:3072 nt lds
    s_add_u32 m0, s21, 32768
    s_mov_b32 s8, s38
    buffer_load_dwordx4 v236, s[4:7], s33 offen nt lds
    buffer_load_dwordx4 v236, s[4:7], s33 offen offset:1024 nt lds
    buffer_load_dwordx4 v236, s[4:7], s33 offen offset:2048 nt lds
    buffer_load_dwordx4 v236, s[4:7], s33 offen offset:3072 nt lds
    s_add_u32 m0, s21, 65536
    s_and_b32 s9, s39, 0xffff
    buffer_load_dwordx4 v236, s[4:7], s34 offen nt lds
    buffer_load_dwordx4 v236, s[4:7], s34 offen offset:1024 nt lds
    buffer_load_dwordx4 v236, s[4:7], s34 offen offset:2048 nt lds
    buffer_load_dwordx4 v236, s[4:7], s34 offen offset:3072 nt lds
    s_mov_b32 s10, 134217728
    s_mov_b32 s11, 0x20000
    s_mov_b32 s12, s40
    s_and_b32 s13, s41, 0xffff
    s_mov_b32 s14, 134217728
    s_mov_b32 s15, 0x20000
    s_mov_b32 s16, s42
    s_and_b32 s17, s43, 0xffff
    s_mov_b32 s18, 50331648
    s_mov_b32 s19, 0x20000
    s_and_b32 s33, s20, 1
    s_lshl_b32 s33, s33, 2
    v_add_u32 v7, s33, v3
    v_lshlrev_b32 v7, 1, v7
    v_xor_b32 v7, v7, v2
    v_lshl_add_u32 v237, v7, 4, v6
    v_lshlrev_b32 v6, 12, v4
    v_lshl_add_u32 v6, v5, 8, v6
    v_xor_b32 v7, v3, v2
    v_lshl_add_u32 v238, v7, 4, v6
    v_xor_b32 v239, 64, v238
    v_xor_b32 v240, 128, v238
    v_xor_b32 v241, 192, v238
    v_lshlrev_b32 v6, 12, v3
    v_lshl_add_u32 v6, v4, 8, v6
    v_and_b32 v7, 1, v3
    v_lshl_add_u32 v7, v7, 2, v4
    v_lshlrev_b32 v7, 1, v7
    v_lshrrev_b32 v8, 1, v5
    v_xor_b32 v7, v7, v8
    v_lshl_add_u32 v6, v7, 4, v6
    v_and_b32 v8, 1, v2
    v_lshl_add_u32 v6, v8, 3, v6
    v_add_u32 v242, 32768, v6
    v_xor_b32 v243, 32, v242
    v_xor_b32 v244, 64, v242
    v_xor_b32 v245, 96, v242
    v_xor_b32 v246, 128, v242
    v_xor_b32 v247, 160, v242
    v_xor_b32 v248, 192, v242
    v_xor_b32 v249, 224, v242
    v_mov_b32 v204, 0x3f803f80
    v_mov_b32 v205, 0x3f803f80
    v_mov_b32 v206, 0x3f803f80
    v_mov_b32 v207, 0x3f803f80
    s_mov_b32 s30, 0x3e0293ee
    s_mov_b32 s35, 0x43800000
    s_mov_b32 s25, 0
    s_mov_b32 s29, s28
    s_setprio 3
    s_mov_b32 s31, 0
    s_mov_b32 s32, 4
L_head:
    v_mbcnt_lo_u32_b32 v164, -1, 0
    v_mbcnt_hi_u32_b32 v164, -1, v164
    v_and_b32 v156, 15, v164
    v_lshrrev_b32 v157, 4, v164
    v_lshlrev_b32 v159, 8, v156
    s_cmp_eq_u32 s25, 2
    s_cbranch_scc1 L_last
    s_lshl_b32 s33, s20, 2
    v_and_b32 v158, 3, v156
    v_add_u32 v158, s33, v158
    v_xor_b32 v158, v158, v157
    v_lshl_add_u32 v165, v158, 4, v159
    v_add_u32 v165, s21, v165
    v_xor_b32 v181, 64, v165
    v_xor_b32 v182, 128, v165
    v_xor_b32 v183, 192, v165
    s_waitcnt vmcnt(8)
    ds_read_b128 v[108:111], v165 offset:0
    ds_read_b128 v[112:115], v181 offset:0
    ds_read_b128 v[116:119], v182 offset:0
    ds_read_b128 v[120:123], v183 offset:0
    s_add_u32 m0, s21, 0
    s_waitcnt lgkmcnt(0)
    buffer_load_dwordx4 v236, s[8:11], s27 offen nt lds
    buffer_load_dwordx4 v236, s[8:11], s27 offen offset:1024 nt lds
    buffer_load_dwordx4 v236, s[8:11], s27 offen offset:2048 nt lds
    buffer_load_dwordx4 v236, s[8:11], s27 offen offset:3072 nt lds
    s_waitcnt vmcnt(8)
    ds_read_b128 v[124:127], v165 offset:32768
    ds_read_b128 v[128:131], v181 offset:32768
    ds_read_b128 v[132:135], v182 offset:32768
    ds_read_b128 v[136:139], v183 offset:32768
    s_add_u32 m0, s21, 32768
    s_waitcnt lgkmcnt(0)
    buffer_load_dwordx4 v237, s[12:15], s27 offen nt lds
    buffer_load_dwordx4 v237, s[12:15], s27 offen offset:1024 nt lds
    buffer_load_dwordx4 v237, s[12:15], s27 offen offset:2048 nt lds
    buffer_load_dwordx4 v237, s[12:15], s27 offen offset:3072 nt lds
    v_add_u32 v165, 65536, v165
    v_add_u32 v181, 65536, v181
    v_add_u32 v182, 65536, v182
    v_add_u32 v183, 65536, v183
    s_waitcnt vmcnt(8)
    ds_read_b128 v[140:143], v165 offset:0
    ds_read_b128 v[144:147], v181 offset:0
    ds_read_b128 v[148:151], v182 offset:0
    ds_read_b128 v[152:155], v183 offset:0
    s_waitcnt lgkmcnt(0)
    v_lshlrev_b32 v208, 16, v108
    v_and_b32 v209, 0xffff0000, v108
    v_mul_f32 v208, s30, v208
    v_mul_f32 v209, s30, v209
    v_cvt_pk_bf16_f32 v108, v208, v209
    v_lshlrev_b32 v210, 16, v109
    v_and_b32 v211, 0xffff0000, v109
    v_mul_f32 v210, s30, v210
    v_mul_f32 v211, s30, v211
    v_cvt_pk_bf16_f32 v109, v210, v211
    v_lshlrev_b32 v212, 16, v110
    v_and_b32 v213, 0xffff0000, v110
    v_mul_f32 v212, s30, v212
    v_mul_f32 v213, s30, v213
    v_cvt_pk_bf16_f32 v110, v212, v213
    v_lshlrev_b32 v208, 16, v111
    v_and_b32 v209, 0xffff0000, v111
    v_mul_f32 v208, s30, v208
    v_mul_f32 v209, s30, v209
    v_cvt_pk_bf16_f32 v111, v208, v209
    v_lshlrev_b32 v210, 16, v112
    v_and_b32 v211, 0xffff0000, v112
    v_mul_f32 v210, s30, v210
    v_mul_f32 v211, s30, v211
    v_cvt_pk_bf16_f32 v112, v210, v211
    v_lshlrev_b32 v212, 16, v113
    v_and_b32 v213, 0xffff0000, v113
    v_mul_f32 v212, s30, v212
    v_mul_f32 v213, s30, v213
    v_cvt_pk_bf16_f32 v113, v212, v213
    v_lshlrev_b32 v208, 16, v114
    v_and_b32 v209, 0xffff0000, v114
    v_mul_f32 v208, s30, v208
    v_mul_f32 v209, s30, v209
    v_cvt_pk_bf16_f32 v114, v208, v209
    v_lshlrev_b32 v210, 16, v115
    v_and_b32 v211, 0xffff0000, v115
    v_mul_f32 v210, s30, v210
    v_mul_f32 v211, s30, v211
    v_cvt_pk_bf16_f32 v115, v210, v211
    v_lshlrev_b32 v212, 16, v116
    v_and_b32 v213, 0xffff0000, v116
    v_mul_f32 v212, s30, v212
    v_mul_f32 v213, s30, v213
    v_cvt_pk_bf16_f32 v116, v212, v213
    v_lshlrev_b32 v208, 16, v117
    v_and_b32 v209, 0xffff0000, v117
    v_mul_f32 v208, s30, v208
    v_mul_f32 v209, s30, v209
    v_cvt_pk_bf16_f32 v117, v208, v209
    v_lshlrev_b32 v210, 16, v118
    v_and_b32 v211, 0xffff0000, v118
    v_mul_f32 v210, s30, v210
    v_mul_f32 v211, s30, v211
    v_cvt_pk_bf16_f32 v118, v210, v211
    v_lshlrev_b32 v212, 16, v119
    v_and_b32 v213, 0xffff0000, v119
    v_mul_f32 v212, s30, v212
    v_mul_f32 v213, s30, v213
    v_cvt_pk_bf16_f32 v119, v212, v213
    v_lshlrev_b32 v208, 16, v120
    v_and_b32 v209, 0xffff0000, v120
    v_mul_f32 v208, s30, v208
    v_mul_f32 v209, s30, v209
    v_cvt_pk_bf16_f32 v120, v208, v209
    v_lshlrev_b32 v210, 16, v121
    v_and_b32 v211, 0xffff0000, v121
    v_mul_f32 v210, s30, v210
    v_mul_f32 v211, s30, v211
    v_cvt_pk_bf16_f32 v121, v210, v211
    v_lshlrev_b32 v212, 16, v122
    v_and_b32 v213, 0xffff0000, v122
    v_mul_f32 v212, s30, v212
    v_mul_f32 v213, s30, v213
    v_cvt_pk_bf16_f32 v122, v212, v213
    v_lshlrev_b32 v208, 16, v123
    v_and_b32 v209, 0xffff0000, v123
    v_mul_f32 v208, s30, v208
    v_mul_f32 v209, s30, v209
    v_cvt_pk_bf16_f32 v123, v208, v209
    v_lshlrev_b32 v210, 16, v124
    v_and_b32 v211, 0xffff0000, v124
    v_mul_f32 v210, s30, v210
    v_mul_f32 v211, s30, v211
    v_cvt_pk_bf16_f32 v124, v210, v211
    v_lshlrev_b32 v212, 16, v125
    v_and_b32 v213, 0xffff0000, v125
    v_mul_f32 v212, s30, v212
    v_mul_f32 v213, s30, v213
    v_cvt_pk_bf16_f32 v125, v212, v213
    v_lshlrev_b32 v208, 16, v126
    v_and_b32 v209, 0xffff0000, v126
    v_mul_f32 v208, s30, v208
    v_mul_f32 v209, s30, v209
    v_cvt_pk_bf16_f32 v126, v208, v209
    v_lshlrev_b32 v210, 16, v127
    v_and_b32 v211, 0xffff0000, v127
    v_mul_f32 v210, s30, v210
    v_mul_f32 v211, s30, v211
    v_cvt_pk_bf16_f32 v127, v210, v211
    v_lshlrev_b32 v212, 16, v128
    v_and_b32 v213, 0xffff0000, v128
    v_mul_f32 v212, s30, v212
    v_mul_f32 v213, s30, v213
    v_cvt_pk_bf16_f32 v128, v212, v213
    v_lshlrev_b32 v208, 16, v129
    v_and_b32 v209, 0xffff0000, v129
    v_mul_f32 v208, s30, v208
    v_mul_f32 v209, s30, v209
    v_cvt_pk_bf16_f32 v129, v208, v209
    v_lshlrev_b32 v210, 16, v130
    v_and_b32 v211, 0xffff0000, v130
    v_mul_f32 v210, s30, v210
    v_mul_f32 v211, s30, v211
    v_cvt_pk_bf16_f32 v130, v210, v211
    v_lshlrev_b32 v212, 16, v131
    v_and_b32 v213, 0xffff0000, v131
    v_mul_f32 v212, s30, v212
    v_mul_f32 v213, s30, v213
    v_cvt_pk_bf16_f32 v131, v212, v213
    v_lshlrev_b32 v208, 16, v132
    v_and_b32 v209, 0xffff0000, v132
    v_mul_f32 v208, s30, v208
    v_mul_f32 v209, s30, v209
    v_cvt_pk_bf16_f32 v132, v208, v209
    v_lshlrev_b32 v210, 16, v133
    v_and_b32 v211, 0xffff0000, v133
    v_mul_f32 v210, s30, v210
    v_mul_f32 v211, s30, v211
    v_cvt_pk_bf16_f32 v133, v210, v211
    v_lshlrev_b32 v212, 16, v134
    v_and_b32 v213, 0xffff0000, v134
    v_mul_f32 v212, s30, v212
    v_mul_f32 v213, s30, v213
    v_cvt_pk_bf16_f32 v134, v212, v213
    v_lshlrev_b32 v208, 16, v135
    v_and_b32 v209, 0xffff0000, v135
    v_mul_f32 v208, s30, v208
    v_mul_f32 v209, s30, v209
    v_cvt_pk_bf16_f32 v135, v208, v209
    v_lshlrev_b32 v210, 16, v136
    v_and_b32 v211, 0xffff0000, v136
    v_mul_f32 v210, s30, v210
    v_mul_f32 v211, s30, v211
    v_cvt_pk_bf16_f32 v136, v210, v211
    v_lshlrev_b32 v212, 16, v137
    v_and_b32 v213, 0xffff0000, v137
    v_mul_f32 v212, s30, v212
    v_mul_f32 v213, s30, v213
    v_cvt_pk_bf16_f32 v137, v212, v213
    v_lshlrev_b32 v208, 16, v138
    v_and_b32 v209, 0xffff0000, v138
    v_mul_f32 v208, s30, v208
    v_mul_f32 v209, s30, v209
    v_cvt_pk_bf16_f32 v138, v208, v209
    v_lshlrev_b32 v210, 16, v139
    v_and_b32 v211, 0xffff0000, v139
    v_mul_f32 v210, s30, v210
    v_mul_f32 v211, s30, v211
    v_cvt_pk_bf16_f32 v139, v210, v211
    v_lshlrev_b32 v212, 16, v140
    v_and_b32 v213, 0xffff0000, v140
    v_mul_f32 v212, s30, v212
    v_mul_f32 v213, s30, v213
    v_cvt_pk_bf16_f32 v140, v212, v213
    v_lshlrev_b32 v208, 16, v141
    v_and_b32 v209, 0xffff0000, v141
    v_mul_f32 v208, s30, v208
    v_mul_f32 v209, s30, v209
    v_cvt_pk_bf16_f32 v141, v208, v209
    v_lshlrev_b32 v210, 16, v142
    v_and_b32 v211, 0xffff0000, v142
    v_mul_f32 v210, s30, v210
    v_mul_f32 v211, s30, v211
    v_cvt_pk_bf16_f32 v142, v210, v211
    v_lshlrev_b32 v212, 16, v143
    v_and_b32 v213, 0xffff0000, v143
    v_mul_f32 v212, s30, v212
    v_mul_f32 v213, s30, v213
    v_cvt_pk_bf16_f32 v143, v212, v213
    v_lshlrev_b32 v208, 16, v144
    v_and_b32 v209, 0xffff0000, v144
    v_mul_f32 v208, s30, v208
    v_mul_f32 v209, s30, v209
    v_cvt_pk_bf16_f32 v144, v208, v209
    v_lshlrev_b32 v210, 16, v145
    v_and_b32 v211, 0xffff0000, v145
    v_mul_f32 v210, s30, v210
    v_mul_f32 v211, s30, v211
    v_cvt_pk_bf16_f32 v145, v210, v211
    v_lshlrev_b32 v212, 16, v146
    v_and_b32 v213, 0xffff0000, v146
    v_mul_f32 v212, s30, v212
    v_mul_f32 v213, s30, v213
    v_cvt_pk_bf16_f32 v146, v212, v213
    v_lshlrev_b32 v208, 16, v147
    v_and_b32 v209, 0xffff0000, v147
    v_mul_f32 v208, s30, v208
    v_mul_f32 v209, s30, v209
    v_cvt_pk_bf16_f32 v147, v208, v209
    v_lshlrev_b32 v210, 16, v148
    v_and_b32 v211, 0xffff0000, v148
    v_mul_f32 v210, s30, v210
    v_mul_f32 v211, s30, v211
    v_cvt_pk_bf16_f32 v148, v210, v211
    v_lshlrev_b32 v212, 16, v149
    v_and_b32 v213, 0xffff0000, v149
    v_mul_f32 v212, s30, v212
    v_mul_f32 v213, s30, v213
    v_cvt_pk_bf16_f32 v149, v212, v213
    v_lshlrev_b32 v208, 16, v150
    v_and_b32 v209, 0xffff0000, v150
    v_mul_f32 v208, s30, v208
    v_mul_f32 v209, s30, v209
    v_cvt_pk_bf16_f32 v150, v208, v209
    v_lshlrev_b32 v210, 16, v151
    v_and_b32 v211, 0xffff0000, v151
    v_mul_f32 v210, s30, v210
    v_mul_f32 v211, s30, v211
    v_cvt_pk_bf16_f32 v151, v210, v211
    v_lshlrev_b32 v212, 16, v152
    v_and_b32 v213, 0xffff0000, v152
    v_mul_f32 v212, s30, v212
    v_mul_f32 v213, s30, v213
    v_cvt_pk_bf16_f32 v152, v212, v213
    v_lshlrev_b32 v208, 16, v153
    v_and_b32 v209, 0xffff0000, v153
    v_mul_f32 v208, s30, v208
    v_mul_f32 v209, s30, v209
    v_cvt_pk_bf16_f32 v153, v208, v209
    v_lshlrev_b32 v210, 16, v154
    v_and_b32 v211, 0xffff0000, v154
    v_mul_f32 v210, s30, v210
    v_mul_f32 v211, s30, v211
    v_cvt_pk_bf16_f32 v154, v210, v211
    v_lshlrev_b32 v212, 16, v155
    v_and_b32 v213, 0xffff0000, v155
    v_mul_f32 v212, s30, v212
    v_mul_f32 v213, s30, v213
    v_cvt_pk_bf16_f32 v155, v212, v213
    s_cmp_eq_u32 s25, 0
    s_cbranch_scc1 L_ohead
    s_add_u32 s34, s21, 65536
    v_lshrrev_b32 v158, 1, v157
    v_xor_b32 v158, v158, v156
    v_lshl_add_u32 v158, v158, 4, v159
    v_and_b32 v161, 1, v157
    v_lshl_add_u32 v162, v161, 3, v158
    v_add_u32 v184, s34, v162
    v_xor_b32 v185, 32, v184
    v_xor_b32 v186, 64, v184
    v_xor_b32 v187, 96, v184
    v_xor_b32 v188, 128, v184
    v_xor_b32 v189, 160, v184
    v_xor_b32 v190, 192, v184
    v_xor_b32 v191, 224, v184
    v_xor_b32 v158, v156, v157
    v_lshlrev_b32 v158, 4, v158
    v_lshl_add_u32 v163, v157, 8, v158
    v_add_u32 v180, s34, v163
    v_xor_b32 v181, 64, v180
    v_xor_b32 v182, 128, v180
    v_xor_b32 v183, 192, v180
    v_lshlrev_b32 v168, 4, v164
    v_add_u32 v168, s21, v168
    ds_write_b64 v184, v[0:1]
    ds_write_b64 v185, v[12:13]
    ds_write_b64 v186, v[24:25]
    ds_write_b64 v187, v[36:37]
    ds_write_b64 v188, v[48:49]
    ds_write_b64 v189, v[60:61]
    ds_write_b64 v190, v[72:73]
    ds_write_b64 v191, v[84:85]
    ds_read_b128 v[220:223], v180 offset:0
    ds_read_b128 v[224:227], v181 offset:1024
    ds_read_b128 v[228:231], v182 offset:2048
    ds_read_b128 v[232:235], v183 offset:3072
    s_add_u32 s33, s29, 0
    s_waitcnt lgkmcnt(3)
    buffer_store_dwordx4 v[220:223], v168, s[16:19], s33 offen offset:0 sc1
    s_waitcnt lgkmcnt(2)
    buffer_store_dwordx4 v[224:227], v168, s[16:19], s33 offen offset:1024 sc1
    s_waitcnt lgkmcnt(1)
    buffer_store_dwordx4 v[228:231], v168, s[16:19], s33 offen offset:2048 sc1
    s_waitcnt lgkmcnt(0)
    buffer_store_dwordx4 v[232:235], v168, s[16:19], s33 offen offset:3072 sc1
    ds_write_b64 v184, v[4:5]
    ds_write_b64 v185, v[16:17]
    ds_write_b64 v186, v[28:29]
    ds_write_b64 v187, v[40:41]
    ds_write_b64 v188, v[52:53]
    ds_write_b64 v189, v[64:65]
    ds_write_b64 v190, v[76:77]
    ds_write_b64 v191, v[88:89]
    ds_read_b128 v[172:175], v180 offset:0
    ds_read_b128 v[176:179], v181 offset:1024
    ds_read_b128 v[192:195], v182 offset:2048
    ds_read_b128 v[196:199], v183 offset:3072
    s_add_u32 s33, s29, 16384
    s_waitcnt lgkmcnt(3)
    buffer_store_dwordx4 v[172:175], v168, s[16:19], s33 offen offset:0 sc1
    s_waitcnt lgkmcnt(2)
    buffer_store_dwordx4 v[176:179], v168, s[16:19], s33 offen offset:1024 sc1
    s_waitcnt lgkmcnt(1)
    buffer_store_dwordx4 v[192:195], v168, s[16:19], s33 offen offset:2048 sc1
    s_waitcnt lgkmcnt(0)
    buffer_store_dwordx4 v[196:199], v168, s[16:19], s33 offen offset:3072 sc1
    ds_write_b64 v184, v[8:9]
    ds_write_b64 v185, v[20:21]
    ds_write_b64 v186, v[32:33]
    ds_write_b64 v187, v[44:45]
    ds_write_b64 v188, v[56:57]
    ds_write_b64 v189, v[68:69]
    ds_write_b64 v190, v[80:81]
    ds_write_b64 v191, v[92:93]
    ds_read_b128 v[220:223], v180 offset:0
    ds_read_b128 v[224:227], v181 offset:1024
    ds_read_b128 v[228:231], v182 offset:2048
    ds_read_b128 v[232:235], v183 offset:3072
    s_add_u32 s33, s29, 32768
    s_waitcnt lgkmcnt(3)
    buffer_store_dwordx4 v[220:223], v168, s[16:19], s33 offen offset:0 sc1
    s_waitcnt lgkmcnt(2)
    buffer_store_dwordx4 v[224:227], v168, s[16:19], s33 offen offset:1024 sc1
    s_waitcnt lgkmcnt(1)
    buffer_store_dwordx4 v[228:231], v168, s[16:19], s33 offen offset:2048 sc1
    s_waitcnt lgkmcnt(0)
    buffer_store_dwordx4 v[232:235], v168, s[16:19], s33 offen offset:3072 sc1
L_ohead:
    s_mov_b32 s29, s28
    s_add_u32 s22, s27, 16384
    s_add_u32 s25, s25, 1
    s_add_u32 s27, s27, 131072
    s_add_u32 s28, s28, 49152
    s_cmp_eq_u32 s25, 2
    s_cselect_b32 s27, 1073741824, s27
    s_cselect_b32 s28, 1073741824, s28
    s_mov_b32 s24, 0
    s_add_u32 m0, s21, 16384
    s_cmp_eq_u32 s25, 1
    s_cbranch_scc1 L_w1_1
    s_waitcnt vmcnt(16)
L_wb_2:
    s_barrier
    ds_read_b128 v[220:223], v238
    ds_read_b128 v[224:227], v239
    ds_read_b128 v[228:231], v240
    ds_read_b128 v[232:235], v241
    buffer_load_dwordx4 v236, s[8:11], s22 offen nt lds
    buffer_load_dwordx4 v236, s[8:11], s22 offen offset:1024 nt lds
    buffer_load_dwordx4 v236, s[8:11], s22 offen offset:2048 nt lds
    buffer_load_dwordx4 v236, s[8:11], s22 offen offset:3072 nt lds
    s_waitcnt lgkmcnt(3)
    v_mfma_f32_16x16x32_bf16 v[156:159], v[220:223], v[108:111], 0
    v_mfma_f32_16x16x32_bf16 v[160:163], v[220:223], v[124:127], 0
    v_mfma_f32_16x16x32_bf16 v[164:167], v[220:223], v[140:143], 0
    ds_read_b128 v[220:223], v238 offset:1024
    s_waitcnt lgkmcnt(3)
    v_mfma_f32_16x16x32_bf16 v[156:159], v[224:227], v[112:115], v[156:159]
    v_mfma_f32_16x16x32_bf16 v[160:163], v[224:227], v[128:131], v[160:163]
    v_mfma_f32_16x16x32_bf16 v[164:167], v[224:227], v[144:147], v[164:167]
    ds_read_b128 v[224:227], v239 offset:1024
    s_waitcnt lgkmcnt(3)
    v_mfma_f32_16x16x32_bf16 v[156:159], v[228:231], v[116:119], v[156:159]
    v_mfma_f32_16x16x32_bf16 v[160:163], v[228:231], v[132:135], v[160:163]
    v_mfma_f32_16x16x32_bf16 v[164:167], v[228:231], v[148:151], v[164:167]
    ds_read_b128 v[228:231], v240 offset:1024
    s_waitcnt lgkmcnt(3)
    v_mfma_f32_16x16x32_bf16 v[156:159], v[232:235], v[120:123], v[156:159]
    v_mfma_f32_16x16x32_bf16 v[160:163], v[232:235], v[136:139], v[160:163]
    v_mfma_f32_16x16x32_bf16 v[164:167], v[232:235], v[152:155], v[164:167]
    ds_read_b128 v[232:235], v241 offset:1024
    s_waitcnt lgkmcnt(3)
    v_mfma_f32_16x16x32_bf16 v[168:171], v[220:223], v[108:111], 0
    v_mfma_f32_16x16x32_bf16 v[172:175], v[220:223], v[124:127], 0
    v_mfma_f32_16x16x32_bf16 v[176:179], v[220:223], v[140:143], 0
    ds_read_b128 v[220:223], v238 offset:2048
    s_waitcnt lgkmcnt(3)
    v_mfma_f32_16x16x32_bf16 v[168:171], v[224:227], v[112:115], v[168:171]
    v_mfma_f32_16x16x32_bf16 v[172:175], v[224:227], v[128:131], v[172:175]
    v_mfma_f32_16x16x32_bf16 v[176:179], v[224:227], v[144:147], v[176:179]
    ds_read_b128 v[224:227], v239 offset:2048
    s_waitcnt lgkmcnt(3)
    v_mfma_f32_16x16x32_bf16 v[168:171], v[228:231], v[116:119], v[168:171]
    v_mfma_f32_16x16x32_bf16 v[172:175], v[228:231], v[132:135], v[172:175]
    v_mfma_f32_16x16x32_bf16 v[176:179], v[228:231], v[148:151], v[176:179]
    ds_read_b128 v[228:231], v240 offset:2048
    s_waitcnt lgkmcnt(3)
    v_mfma_f32_16x16x32_bf16 v[168:171], v[232:235], v[120:123], v[168:171]
    v_mfma_f32_16x16x32_bf16 v[172:175], v[232:235], v[136:139], v[172:175]
    v_mfma_f32_16x16x32_bf16 v[176:179], v[232:235], v[152:155], v[176:179]
    ds_read_b128 v[232:235], v241 offset:2048
    s_waitcnt lgkmcnt(3)
    v_mfma_f32_16x16x32_bf16 v[180:183], v[220:223], v[108:111], 0
    v_mfma_f32_16x16x32_bf16 v[184:187], v[220:223], v[124:127], 0
    v_mfma_f32_16x16x32_bf16 v[188:191], v[220:223], v[140:143], 0
    ds_read_b128 v[220:223], v238 offset:3072
    s_waitcnt lgkmcnt(3)
    v_mfma_f32_16x16x32_bf16 v[180:183], v[224:227], v[112:115], v[180:183]
    v_mfma_f32_16x16x32_bf16 v[184:187], v[224:227], v[128:131], v[184:187]
    v_mfma_f32_16x16x32_bf16 v[188:191], v[224:227], v[144:147], v[188:191]
    ds_read_b128 v[224:227], v239 offset:3072
    s_waitcnt lgkmcnt(3)
    v_mfma_f32_16x16x32_bf16 v[180:183], v[228:231], v[116:119], v[180:183]
    v_mfma_f32_16x16x32_bf16 v[184:187], v[228:231], v[132:135], v[184:187]
    v_mfma_f32_16x16x32_bf16 v[188:191], v[228:231], v[148:151], v[188:191]
    ds_read_b128 v[228:231], v240 offset:3072
    s_waitcnt lgkmcnt(3)
    v_mfma_f32_16x16x32_bf16 v[180:183], v[232:235], v[120:123], v[180:183]
    v_mfma_f32_16x16x32_bf16 v[184:187], v[232:235], v[136:139], v[184:187]
    v_mfma_f32_16x16x32_bf16 v[188:191], v[232:235], v[152:155], v[188:191]
    ds_read_b128 v[232:235], v241 offset:3072
    s_waitcnt lgkmcnt(3)
    v_mfma_f32_16x16x32_bf16 v[192:195], v[220:223], v[108:111], 0
    v_mfma_f32_16x16x32_bf16 v[196:199], v[220:223], v[124:127], 0
    v_mfma_f32_16x16x32_bf16 v[200:203], v[220:223], v[140:143], 0
    s_waitcnt lgkmcnt(2)
    v_mfma_f32_16x16x32_bf16 v[192:195], v[224:227], v[112:115], v[192:195]
    v_mfma_f32_16x16x32_bf16 v[196:199], v[224:227], v[128:131], v[196:199]
    v_mfma_f32_16x16x32_bf16 v[200:203], v[224:227], v[144:147], v[200:203]
    s_waitcnt lgkmcnt(1)
    v_mfma_f32_16x16x32_bf16 v[192:195], v[228:231], v[116:119], v[192:195]
    v_mfma_f32_16x16x32_bf16 v[196:199], v[228:231], v[132:135], v[196:199]
    v_mfma_f32_16x16x32_bf16 v[200:203], v[228:231], v[148:151], v[200:203]
    s_waitcnt lgkmcnt(0)
    v_mfma_f32_16x16x32_bf16 v[192:195], v[232:235], v[120:123], v[192:195]
    v_mfma_f32_16x16x32_bf16 v[196:199], v[232:235], v[136:139], v[196:199]
    v_mfma_f32_16x16x32_bf16 v[200:203], v[232:235], v[152:155], v[200:203]
    v_max3_f32 v209, v156, v157, v158
    v_max3_f32 v213, v160, v161, v162
    v_max3_f32 v217, v164, v165, v166
    v_max3_f32 v209, v209, v159, v168
    v_max3_f32 v213, v213, v163, v172
    v_max3_f32 v217, v217, v167, v176
    v_max3_f32 v209, v209, v169, v170
    v_max3_f32 v213, v213, v173, v174
    v_max3_f32 v217, v217, v177, v178
    v_max3_f32 v209, v209, v171, v180
    v_max3_f32 v213, v213, v175, v184
    v_max3_f32 v217, v217, v179, v188
    v_max3_f32 v209, v209, v181, v182
    v_max3_f32 v213, v213, v185, v186
    v_max3_f32 v217, v217, v189, v190
    v_max3_f32 v209, v209, v183, v192
    v_max3_f32 v213, v213, v187, v196
    v_max3_f32 v217, v217, v191, v200
    v_max3_f32 v209, v209, v193, v194
    v_max3_f32 v213, v213, v197, v198
    v_max3_f32 v217, v217, v201, v202
    v_max_f32 v209, v209, v195
    v_max_f32 v213, v213, v199
    v_max_f32 v217, v217, v203
    v_mov_b32 v210, v209
    v_mov_b32 v214, v213
    v_mov_b32 v218, v217
    s_nop 1
    v_permlane16_swap_b32 v209, v210
    v_permlane16_swap_b32 v213, v214
    v_permlane16_swap_b32 v217, v218
    v_max_f32 v209, v209, v210
    v_max_f32 v213, v213, v214
    v_max_f32 v217, v217, v218
    v_mov_b32 v210, v209
    v_mov_b32 v214, v213
    v_mov_b32 v218, v217
    s_nop 1
    v_permlane32_swap_b32 v209, v210
    v_permlane32_swap_b32 v213, v214
    v_permlane32_swap_b32 v217, v218
    v_max_f32 v209, v209, v210
    v_max_f32 v213, v213, v214
    v_max_f32 v217, v217, v218
    v_sub_f32 v209, 0xc0e00000, v209
    v_sub_f32 v213, 0xc0e00000, v213
    v_sub_f32 v217, 0xc0e00000, v217
    v_mov_b32 v208, v209
    v_mov_b32 v210, v209
    v_mov_b32 v211, v209
    v_mov_b32 v212, v213
    v_mov_b32 v214, v213
    v_mov_b32 v215, v213
    v_mov_b32 v216, v217
    v_mov_b32 v218, v217
    v_mov_b32 v219, v217
    v_add_f32 v156, v156, v208
    v_add_f32 v157, v157, v208
    v_add_f32 v158, v158, v208
    v_add_f32 v159, v159, v208
    v_add_f32 v168, v168, v208
    v_add_f32 v169, v169, v208
    v_add_f32 v170, v170, v208
    v_add_f32 v171, v171, v208
    v_add_f32 v180, v180, v208
    v_add_f32 v181, v181, v208
    v_add_f32 v182, v182, v208
    v_add_f32 v183, v183, v208
    v_add_f32 v192, v192, v208
    v_add_f32 v193, v193, v208
    v_add_f32 v194, v194, v208
    v_add_f32 v195, v195, v208
    v_add_f32 v160, v160, v212
    v_add_f32 v161, v161, v212
    v_add_f32 v162, v162, v212
    v_add_f32 v163, v163, v212
    v_add_f32 v172, v172, v212
    v_add_f32 v173, v173, v212
    v_add_f32 v174, v174, v212
    v_add_f32 v175, v175, v212
    v_add_f32 v184, v184, v212
    v_add_f32 v185, v185, v212
    v_add_f32 v186, v186, v212
    v_add_f32 v187, v187, v212
    v_add_f32 v196, v196, v212
    v_add_f32 v197, v197, v212
    v_add_f32 v198, v198, v212
    v_add_f32 v199, v199, v212
    v_add_f32 v164, v164, v216
    v_add_f32 v165, v165, v216
    v_add_f32 v166, v166, v216
    v_add_f32 v167, v167, v216
    v_add_f32 v176, v176, v216
    v_add_f32 v177, v177, v216
    v_add_f32 v178, v178, v216
    v_add_f32 v179, v179, v216
    v_add_f32 v188, v188, v216
    v_add_f32 v189, v189, v216
    v_add_f32 v190, v190, v216
    v_add_f32 v191, v191, v216
    v_add_f32 v200, v200, v216
    v_add_f32 v201, v201, v216
    v_add_f32 v202, v202, v216
    v_add_f32 v203, v203, v216
    v_exp_f32 v156, v156
    v_exp_f32 v157, v157
    v_exp_f32 v158, v158
    v_exp_f32 v159, v159
    v_exp_f32 v168, v168
    v_exp_f32 v169, v169
    v_exp_f32 v170, v170
    v_exp_f32 v171, v171
    v_exp_f32 v160, v160
    v_exp_f32 v161, v161
    v_exp_f32 v162, v162
    v_exp_f32 v163, v163
    v_cvt_pk_bf16_f32 v156, v156, v157
    v_cvt_pk_bf16_f32 v157, v158, v159
    v_exp_f32 v172, v172
    v_exp_f32 v173, v173
    v_exp_f32 v174, v174
    v_exp_f32 v175, v175
    v_cvt_pk_bf16_f32 v158, v168, v169
    v_cvt_pk_bf16_f32 v159, v170, v171
    v_exp_f32 v164, v164
    v_exp_f32 v165, v165
    v_exp_f32 v166, v166
    v_exp_f32 v167, v167
    v_cvt_pk_bf16_f32 v160, v160, v161
    v_cvt_pk_bf16_f32 v161, v162, v163
    v_exp_f32 v176, v176
    v_exp_f32 v177, v177
    v_exp_f32 v178, v178
    v_exp_f32 v179, v179
    v_cvt_pk_bf16_f32 v162, v172, v173
    v_cvt_pk_bf16_f32 v163, v174, v175
    v_cvt_pk_bf16_f32 v164, v164, v165
    v_cvt_pk_bf16_f32 v165, v166, v167
    v_cvt_pk_bf16_f32 v166, v176, v177
    v_cvt_pk_bf16_f32 v167, v178, v179
    v_mfma_f32_16x16x32_bf16 v[96:99], v[204:207], v[156:159], 0
    v_mfma_f32_16x16x32_bf16 v[100:103], v[204:207], v[160:163], 0
    v_mfma_f32_16x16x32_bf16 v[104:107], v[204:207], v[164:167], 0
    v_exp_f32 v180, v180
    v_exp_f32 v181, v181
    v_exp_f32 v182, v182
    v_exp_f32 v183, v183
    v_exp_f32 v192, v192
    v_exp_f32 v193, v193
    v_exp_f32 v194, v194
    v_exp_f32 v195, v195
    v_exp_f32 v184, v184
    v_exp_f32 v185, v185
    v_exp_f32 v186, v186
    v_exp_f32 v187, v187
    v_cvt_pk_bf16_f32 v180, v180, v181
    v_cvt_pk_bf16_f32 v181, v182, v183
    v_exp_f32 v196, v196
    v_exp_f32 v197, v197
    v_exp_f32 v198, v198
    v_exp_f32 v199, v199
    v_cvt_pk_bf16_f32 v182, v192, v193
    v_cvt_pk_bf16_f32 v183, v194, v195
    v_exp_f32 v188, v188
    v_exp_f32 v189, v189
    v_exp_f32 v190, v190
    v_exp_f32 v191, v191
    v_cvt_pk_bf16_f32 v184, v184, v185
    v_cvt_pk_bf16_f32 v185, v186, v187
    v_exp_f32 v200, v200
    v_exp_f32 v201, v201
    v_exp_f32 v202, v202
    v_exp_f32 v203, v203
    v_cvt_pk_bf16_f32 v186, v196, v197
    v_cvt_pk_bf16_f32 v187, v198, v199
    v_cvt_pk_bf16_f32 v188, v188, v189
    v_cvt_pk_bf16_f32 v189, v190, v191
    v_cvt_pk_bf16_f32 v190, v200, v201
    v_cvt_pk_bf16_f32 v191, v202, v203
    v_mfma_f32_16x16x32_bf16 v[96:99], v[204:207], v[180:183], v[96:99]
    v_mfma_f32_16x16x32_bf16 v[100:103], v[204:207], v[184:187], v[100:103]
    v_mfma_f32_16x16x32_bf16 v[104:107], v[204:207], v[188:191], v[104:107]
    s_add_u32 m0, s21, 49152
    s_cmp_eq_u32 s25, 1
    s_cbranch_scc1 L_w1_3
    s_waitcnt vmcnt(16)
L_wb_4:
    s_barrier
    ds_read_b64_tr_b16 v[220:221], v242
    ds_read_b64_tr_b16 v[222:223], v242 offset:1024
    ds_read_b64_tr_b16 v[224:225], v243
    ds_read_b64_tr_b16 v[226:227], v243 offset:1024
    ds_read_b64_tr_b16 v[228:229], v244
    ds_read_b64_tr_b16 v[230:231], v244 offset:1024
    ds_read_b64_tr_b16 v[232:233], v245
    ds_read_b64_tr_b16 v[234:235], v245 offset:1024
    buffer_load_dwordx4 v237, s[12:15], s22 offen nt lds
    buffer_load_dwordx4 v237, s[12:15], s22 offen offset:1024 nt lds
    buffer_load_dwordx4 v237, s[12:15], s22 offen offset:2048 nt lds
    buffer_load_dwordx4 v237, s[12:15], s22 offen offset:3072 nt lds
    v_mov_b32 v250, v96
    v_mov_b32 v251, v100
    v_mov_b32 v252, v104
    s_waitcnt lgkmcnt(6)
    v_mfma_f32_16x16x32_bf16 v[0:3], v[220:223], v[156:159], 0
    v_mfma_f32_16x16x32_bf16 v[4:7], v[220:223], v[160:163], 0
    v_mfma_f32_16x16x32_bf16 v[8:11], v[220:223], v[164:167], 0
    ds_read_b64_tr_b16 v[220:221], v246
    ds_read_b64_tr_b16 v[222:223], v246 offset:1024
    s_waitcnt lgkmcnt(6)
    v_mfma_f32_16x16x32_bf16 v[12:15], v[224:227], v[156:159], 0
    v_mfma_f32_16x16x32_bf16 v[16:19], v[224:227], v[160:163], 0
    v_mfma_f32_16x16x32_bf16 v[20:23], v[224:227], v[164:167], 0
    ds_read_b64_tr_b16 v[224:225], v247
    ds_read_b64_tr_b16 v[226:227], v247 offset:1024
    s_waitcnt lgkmcnt(6)
    v_mfma_f32_16x16x32_bf16 v[24:27], v[228:231], v[156:159], 0
    v_mfma_f32_16x16x32_bf16 v[28:31], v[228:231], v[160:163], 0
    v_mfma_f32_16x16x32_bf16 v[32:35], v[228:231], v[164:167], 0
    ds_read_b64_tr_b16 v[228:229], v248
    ds_read_b64_tr_b16 v[230:231], v248 offset:1024
    s_waitcnt lgkmcnt(6)
    v_mfma_f32_16x16x32_bf16 v[36:39], v[232:235], v[156:159], 0
    v_mfma_f32_16x16x32_bf16 v[40:43], v[232:235], v[160:163], 0
    v_mfma_f32_16x16x32_bf16 v[44:47], v[232:235], v[164:167], 0
    ds_read_b64_tr_b16 v[232:233], v249
    ds_read_b64_tr_b16 v[234:235], v249 offset:1024
    s_waitcnt lgkmcnt(6)
    v_mfma_f32_16x16x32_bf16 v[48:51], v[220:223], v[156:159], 0
    v_mfma_f32_16x16x32_bf16 v[52:55], v[220:223], v[160:163], 0
    v_mfma_f32_16x16x32_bf16 v[56:59], v[220:223], v[164:167], 0
    ds_read_b64_tr_b16 v[220:221], v242 offset:2048
    ds_read_b64_tr_b16 v[222:223], v242 offset:3072
    s_waitcnt lgkmcnt(6)
    v_mfma_f32_16x16x32_bf16 v[60:63], v[224:227], v[156:159], 0
    v_mfma_f32_16x16x32_bf16 v[64:67], v[224:227], v[160:163], 0
    v_mfma_f32_16x16x32_bf16 v[68:71], v[224:227], v[164:167], 0
    ds_read_b64_tr_b16 v[224:225], v243 offset:2048
    ds_read_b64_tr_b16 v[226:227], v243 offset:3072
    s_waitcnt lgkmcnt(6)
    v_mfma_f32_16x16x32_bf16 v[72:75], v[228:231], v[156:159], 0
    v_mfma_f32_16x16x32_bf16 v[76:79], v[228:231], v[160:163], 0
    v_mfma_f32_16x16x32_bf16 v[80:83], v[228:231], v[164:167], 0
    ds_read_b64_tr_b16 v[228:229], v244 offset:2048
    ds_read_b64_tr_b16 v[230:231], v244 offset:3072
    s_waitcnt lgkmcnt(6)
    v_mfma_f32_16x16x32_bf16 v[84:87], v[232:235], v[156:159], 0
    v_mfma_f32_16x16x32_bf16 v[88:91], v[232:235], v[160:163], 0
    v_mfma_f32_16x16x32_bf16 v[92:95], v[232:235], v[164:167], 0
    ds_read_b64_tr_b16 v[232:233], v245 offset:2048
    ds_read_b64_tr_b16 v[234:235], v245 offset:3072
    s_waitcnt lgkmcnt(6)
    v_mfma_f32_16x16x32_bf16 v[0:3], v[220:223], v[180:183], v[0:3]
    v_mfma_f32_16x16x32_bf16 v[4:7], v[220:223], v[184:187], v[4:7]
    v_mfma_f32_16x16x32_bf16 v[8:11], v[220:223], v[188:191], v[8:11]
    ds_read_b64_tr_b16 v[220:221], v246 offset:2048
    ds_read_b64_tr_b16 v[222:223], v246 offset:3072
    s_waitcnt lgkmcnt(6)
    v_mfma_f32_16x16x32_bf16 v[12:15], v[224:227], v[180:183], v[12:15]
    v_mfma_f32_16x16x32_bf16 v[16:19], v[224:227], v[184:187], v[16:19]
    v_mfma_f32_16x16x32_bf16 v[20:23], v[224:227], v[188:191], v[20:23]
    ds_read_b64_tr_b16 v[224:225], v247 offset:2048
    ds_read_b64_tr_b16 v[226:227], v247 offset:3072
    s_waitcnt lgkmcnt(6)
    v_mfma_f32_16x16x32_bf16 v[24:27], v[228:231], v[180:183], v[24:27]
    v_mfma_f32_16x16x32_bf16 v[28:31], v[228:231], v[184:187], v[28:31]
    v_mfma_f32_16x16x32_bf16 v[32:35], v[228:231], v[188:191], v[32:35]
    ds_read_b64_tr_b16 v[228:229], v248 offset:2048
    ds_read_b64_tr_b16 v[230:231], v248 offset:3072
    s_waitcnt lgkmcnt(6)
    v_mfma_f32_16x16x32_bf16 v[36:39], v[232:235], v[180:183], v[36:39]
    v_mfma_f32_16x16x32_bf16 v[40:43], v[232:235], v[184:187], v[40:43]
    v_mfma_f32_16x16x32_bf16 v[44:47], v[232:235], v[188:191], v[44:47]
    ds_read_b64_tr_b16 v[232:233], v249 offset:2048
    ds_read_b64_tr_b16 v[234:235], v249 offset:3072
    s_waitcnt lgkmcnt(6)
    v_mfma_f32_16x16x32_bf16 v[48:51], v[220:223], v[180:183], v[48:51]
    v_mfma_f32_16x16x32_bf16 v[52:55], v[220:223], v[184:187], v[52:55]
    v_mfma_f32_16x16x32_bf16 v[56:59], v[220:223], v[188:191], v[56:59]
    s_waitcnt lgkmcnt(4)
    v_mfma_f32_16x16x32_bf16 v[60:63], v[224:227], v[180:183], v[60:63]
    v_mfma_f32_16x16x32_bf16 v[64:67], v[224:227], v[184:187], v[64:67]
    v_mfma_f32_16x16x32_bf16 v[68:71], v[224:227], v[188:191], v[68:71]
    s_waitcnt lgkmcnt(2)
    v_mfma_f32_16x16x32_bf16 v[72:75], v[228:231], v[180:183], v[72:75]
    v_mfma_f32_16x16x32_bf16 v[76:79], v[228:231], v[184:187], v[76:79]
    v_mfma_f32_16x16x32_bf16 v[80:83], v[228:231], v[188:191], v[80:83]
    s_waitcnt lgkmcnt(0)
    v_mfma_f32_16x16x32_bf16 v[84:87], v[232:235], v[180:183], v[84:87]
    v_mfma_f32_16x16x32_bf16 v[88:91], v[232:235], v[184:187], v[88:91]
    v_mfma_f32_16x16x32_bf16 v[92:95], v[232:235], v[188:191], v[92:95]
    s_add_u32 s24, s24, 1
    s_add_u32 s22, s22, 16384
    s_add_u32 s31, s31, 1
    s_cmp_eq_u32 s31, s32
    s_cbranch_scc1 L_pp_5
L_pb_6:
L_loop:
    s_add_u32 m0, s21, 0
    s_waitcnt vmcnt(4)
    s_barrier
    ds_read_b128 v[220:223], v238 offset:16384
    ds_read_b128 v[224:227], v239 offset:16384
    ds_read_b128 v[228:231], v240 offset:16384
    ds_read_b128 v[232:235], v241 offset:16384
    s_cmp_eq_u32 s24, 7
    s_cbranch_scc1 L_rq_9
    buffer_load_dwordx4 v236, s[8:11], s22 offen nt lds
    buffer_load_dwordx4 v236, s[8:11], s22 offen offset:1024 nt lds
    buffer_load_dwordx4 v236, s[8:11], s22 offen offset:2048 nt lds
    buffer_load_dwordx4 v236, s[8:11], s22 offen offset:3072 nt lds
L_rb_10:
    s_waitcnt lgkmcnt(3)
    v_mfma_f32_16x16x32_bf16 v[156:159], v[220:223], v[108:111], v[208:211]
    v_mfma_f32_16x16x32_bf16 v[160:163], v[220:223], v[124:127], v[212:215]
    v_mfma_f32_16x16x32_bf16 v[164:167], v[220:223], v[140:143], v[216:219]
    ds_read_b128 v[220:223], v238 offset:17408
    s_waitcnt lgkmcnt(3)
    v_mfma_f32_16x16x32_bf16 v[156:159], v[224:227], v[112:115], v[156:159]
    v_mfma_f32_16x16x32_bf16 v[160:163], v[224:227], v[128:131], v[160:163]
    v_mfma_f32_16x16x32_bf16 v[164:167], v[224:227], v[144:147], v[164:167]
    ds_read_b128 v[224:227], v239 offset:17408
    s_waitcnt lgkmcnt(3)
    v_mfma_f32_16x16x32_bf16 v[156:159], v[228:231], v[116:119], v[156:159]
    v_mfma_f32_16x16x32_bf16 v[160:163], v[228:231], v[132:135], v[160:163]
    v_mfma_f32_16x16x32_bf16 v[164:167], v[228:231], v[148:151], v[164:167]
    ds_read_b128 v[228:231], v240 offset:17408
    s_waitcnt lgkmcnt(3)
    v_mfma_f32_16x16x32_bf16 v[156:159], v[232:235], v[120:123], v[156:159]
    v_mfma_f32_16x16x32_bf16 v[160:163], v[232:235], v[136:139], v[160:163]
    v_mfma_f32_16x16x32_bf16 v[164:167], v[232:235], v[152:155], v[164:167]
    ds_read_b128 v[232:235], v241 offset:17408
    s_waitcnt lgkmcnt(3)
    v_mfma_f32_16x16x32_bf16 v[168:171], v[220:223], v[108:111], v[208:211]
    v_mfma_f32_16x16x32_bf16 v[172:175], v[220:223], v[124:127], v[212:215]
    v_mfma_f32_16x16x32_bf16 v[176:179], v[220:223], v[140:143], v[216:219]
    ds_read_b128 v[220:223], v238 offset:18432
    s_waitcnt lgkmcnt(3)
    v_mfma_f32_16x16x32_bf16 v[168:171], v[224:227], v[112:115], v[168:171]
    v_mfma_f32_16x16x32_bf16 v[172:175], v[224:227], v[128:131], v[172:175]
    v_mfma_f32_16x16x32_bf16 v[176:179], v[224:227], v[144:147], v[176:179]
    ds_read_b128 v[224:227], v239 offset:18432
    s_waitcnt lgkmcnt(3)
    v_mfma_f32_16x16x32_bf16 v[168:171], v[228:231], v[116:119], v[168:171]
    v_mfma_f32_16x16x32_bf16 v[172:175], v[228:231], v[132:135], v[172:175]
    v_mfma_f32_16x16x32_bf16 v[176:179], v[228:231], v[148:151], v[176:179]
    ds_read_b128 v[228:231], v240 offset:18432
    s_waitcnt lgkmcnt(3)
    v_mfma_f32_16x16x32_bf16 v[168:171], v[232:235], v[120:123], v[168:171]
    v_mfma_f32_16x16x32_bf16 v[172:175], v[232:235], v[136:139], v[172:175]
    v_mfma_f32_16x16x32_bf16 v[176:179], v[232:235], v[152:155], v[176:179]
    ds_read_b128 v[232:235], v241 offset:18432
    s_waitcnt lgkmcnt(3)
    v_mfma_f32_16x16x32_bf16 v[180:183], v[220:223], v[108:111], v[208:211]
    v_mfma_f32_16x16x32_bf16 v[184:187], v[220:223], v[124:127], v[212:215]
    v_mfma_f32_16x16x32_bf16 v[188:191], v[220:223], v[140:143], v[216:219]
    ds_read_b128 v[220:223], v238 offset:19456
    s_waitcnt lgkmcnt(3)
    v_mfma_f32_16x16x32_bf16 v[180:183], v[224:227], v[112:115], v[180:183]
    v_mfma_f32_16x16x32_bf16 v[184:187], v[224:227], v[128:131], v[184:187]
    v_mfma_f32_16x16x32_bf16 v[188:191], v[224:227], v[144:147], v[188:191]
    ds_read_b128 v[224:227], v239 offset:19456
    s_waitcnt lgkmcnt(3)
    v_mfma_f32_16x16x32_bf16 v[180:183], v[228:231], v[116:119], v[180:183]
    v_mfma_f32_16x16x32_bf16 v[184:187], v[228:231], v[132:135], v[184:187]
    v_mfma_f32_16x16x32_bf16 v[188:191], v[228:231], v[148:151], v[188:191]
    ds_read_b128 v[228:231], v240 offset:19456
    s_waitcnt lgkmcnt(3)
    v_mfma_f32_16x16x32_bf16 v[180:183], v[232:235], v[120:123], v[180:183]
    v_mfma_f32_16x16x32_bf16 v[184:187], v[232:235], v[136:139], v[184:187]
    v_mfma_f32_16x16x32_bf16 v[188:191], v[232:235], v[152:155], v[188:191]
    ds_read_b128 v[232:235], v241 offset:19456
    s_waitcnt lgkmcnt(3)
    v_mfma_f32_16x16x32_bf16 v[192:195], v[220:223], v[108:111], v[208:211]
    v_mfma_f32_16x16x32_bf16 v[196:199], v[220:223], v[124:127], v[212:215]
    v_mfma_f32_16x16x32_bf16 v[200:203], v[220:223], v[140:143], v[216:219]
    s_waitcnt lgkmcnt(2)
    v_mfma_f32_16x16x32_bf16 v[192:195], v[224:227], v[112:115], v[192:195]
    v_mfma_f32_16x16x32_bf16 v[196:199], v[224:227], v[128:131], v[196:199]
    v_mfma_f32_16x16x32_bf16 v[200:203], v[224:227], v[144:147], v[200:203]
    s_waitcnt lgkmcnt(1)
    v_mfma_f32_16x16x32_bf16 v[192:195], v[228:231], v[116:119], v[192:195]
    v_mfma_f32_16x16x32_bf16 v[196:199], v[228:231], v[132:135], v[196:199]
    v_mfma_f32_16x16x32_bf16 v[200:203], v[228:231], v[148:151], v[200:203]
    s_waitcnt lgkmcnt(0)
    v_mfma_f32_16x16x32_bf16 v[192:195], v[232:235], v[120:123], v[192:195]
    v_mfma_f32_16x16x32_bf16 v[196:199], v[232:235], v[136:139], v[196:199]
    v_mfma_f32_16x16x32_bf16 v[200:203], v[232:235], v[152:155], v[200:203]
    v_exp_f32 v156, v156
    v_exp_f32 v157, v157
    v_exp_f32 v158, v158
    v_exp_f32 v159, v159
    v_exp_f32 v168, v168
    v_exp_f32 v169, v169
    v_exp_f32 v170, v170
    v_exp_f32 v171, v171
    v_exp_f32 v160, v160
    v_exp_f32 v161, v161
    v_exp_f32 v162, v162
    v_exp_f32 v163, v163
    v_cvt_pk_bf16_f32 v156, v156, v157
    v_cvt_pk_bf16_f32 v157, v158, v159
    v_exp_f32 v172, v172
    v_exp_f32 v173, v173
    v_exp_f32 v174, v174
    v_exp_f32 v175, v175
    v_cvt_pk_bf16_f32 v158, v168, v169
    v_cvt_pk_bf16_f32 v159, v170, v171
    v_exp_f32 v164, v164
    v_exp_f32 v165, v165
    v_exp_f32 v166, v166
    v_exp_f32 v167, v167
    v_cvt_pk_bf16_f32 v160, v160, v161
    v_cvt_pk_bf16_f32 v161, v162, v163
    v_exp_f32 v176, v176
    v_exp_f32 v177, v177
    v_exp_f32 v178, v178
    v_exp_f32 v179, v179
    v_cvt_pk_bf16_f32 v162, v172, v173
    v_cvt_pk_bf16_f32 v163, v174, v175
    v_cvt_pk_bf16_f32 v164, v164, v165
    v_cvt_pk_bf16_f32 v165, v166, v167
    v_cvt_pk_bf16_f32 v166, v176, v177
    v_cvt_pk_bf16_f32 v167, v178, v179
    v_mfma_f32_16x16x32_bf16 v[96:99], v[204:207], v[156:159], 0
    v_mfma_f32_16x16x32_bf16 v[100:103], v[204:207], v[160:163], 0
    v_mfma_f32_16x16x32_bf16 v[104:107], v[204:207], v[164:167], 0
    v_exp_f32 v180, v180
    v_exp_f32 v181, v181
    v_exp_f32 v182, v182
    v_exp_f32 v183, v183
    v_exp_f32 v192, v192
    v_exp_f32 v193, v193
    v_exp_f32 v194, v194
    v_exp_f32 v195, v195
    v_exp_f32 v184, v184
    v_exp_f32 v185, v185
    v_exp_f32 v186, v186
    v_exp_f32 v187, v187
    v_cvt_pk_bf16_f32 v180, v180, v181
    v_cvt_pk_bf16_f32 v181, v182, v183
    v_exp_f32 v196, v196
    v_exp_f32 v197, v197
    v_exp_f32 v198, v198
    v_exp_f32 v199, v199
    v_cvt_pk_bf16_f32 v182, v192, v193
    v_cvt_pk_bf16_f32 v183, v194, v195
    v_exp_f32 v188, v188
    v_exp_f32 v189, v189
    v_exp_f32 v190, v190
    v_exp_f32 v191, v191
    v_cvt_pk_bf16_f32 v184, v184, v185
    v_cvt_pk_bf16_f32 v185, v186, v187
    v_exp_f32 v200, v200
    v_exp_f32 v201, v201
    v_exp_f32 v202, v202
    v_exp_f32 v203, v203
    v_cvt_pk_bf16_f32 v186, v196, v197
    v_cvt_pk_bf16_f32 v187, v198, v199
    v_cvt_pk_bf16_f32 v188, v188, v189
    v_cvt_pk_bf16_f32 v189, v190, v191
    v_cvt_pk_bf16_f32 v190, v200, v201
    v_cvt_pk_bf16_f32 v191, v202, v203
    v_mfma_f32_16x16x32_bf16 v[96:99], v[204:207], v[180:183], v[96:99]
    v_mfma_f32_16x16x32_bf16 v[100:103], v[204:207], v[184:187], v[100:103]
    v_mfma_f32_16x16x32_bf16 v[104:107], v[204:207], v[188:191], v[104:107]
    s_add_u32 m0, s21, 32768
    s_waitcnt vmcnt(4)
    s_barrier
    ds_read_b64_tr_b16 v[220:221], v242 offset:16384
    ds_read_b64_tr_b16 v[222:223], v242 offset:17408
    ds_read_b64_tr_b16 v[224:225], v243 offset:16384
    ds_read_b64_tr_b16 v[226:227], v243 offset:17408
    ds_read_b64_tr_b16 v[228:229], v244 offset:16384
    ds_read_b64_tr_b16 v[230:231], v244 offset:17408
    ds_read_b64_tr_b16 v[232:233], v245 offset:16384
    ds_read_b64_tr_b16 v[234:235], v245 offset:17408
    s_cmp_eq_u32 s24, 7
    s_cbranch_scc1 L_vq_11
    buffer_load_dwordx4 v237, s[12:15], s22 offen nt lds
    buffer_load_dwordx4 v237, s[12:15], s22 offen offset:1024 nt lds
    buffer_load_dwordx4 v237, s[12:15], s22 offen offset:2048 nt lds
    buffer_load_dwordx4 v237, s[12:15], s22 offen offset:3072 nt lds
L_vb_12:
    v_max3_f32 v253, v96, v100, v104
    v_cmp_nge_f32 vcc, s35, v253
    s_cbranch_vccnz L_redo1
L_pv1:
    v_add_f32 v250, v250, v96
    v_add_f32 v251, v251, v100
    v_add_f32 v252, v252, v104
    s_cmp_eq_u32 s24, 7
    s_cbranch_scc1 L_vlast
    s_waitcnt lgkmcnt(6)
    v_mfma_f32_16x16x32_bf16 v[0:3], v[220:223], v[156:159], v[0:3]
    v_mfma_f32_16x16x32_bf16 v[4:7], v[220:223], v[160:163], v[4:7]
    v_mfma_f32_16x16x32_bf16 v[8:11], v[220:223], v[164:167], v[8:11]
    ds_read_b64_tr_b16 v[220:221], v246 offset:16384
    ds_read_b64_tr_b16 v[222:223], v246 offset:17408
    s_waitcnt lgkmcnt(6)
    v_mfma_f32_16x16x32_bf16 v[12:15], v[224:227], v[156:159], v[12:15]
    v_mfma_f32_16x16x32_bf16 v[16:19], v[224:227], v[160:163], v[16:19]
    v_mfma_f32_16x16x32_bf16 v[20:23], v[224:227], v[164:167], v[20:23]
    ds_read_b64_tr_b16 v[224:225], v247 offset:16384
    ds_read_b64_tr_b16 v[226:227], v247 offset:17408
    s_waitcnt lgkmcnt(6)
    v_mfma_f32_16x16x32_bf16 v[24:27], v[228:231], v[156:159], v[24:27]
    v_mfma_f32_16x16x32_bf16 v[28:31], v[228:231], v[160:163], v[28:31]
    v_mfma_f32_16x16x32_bf16 v[32:35], v[228:231], v[164:167], v[32:35]
    ds_read_b64_tr_b16 v[228:229], v248 offset:16384
    ds_read_b64_tr_b16 v[230:231], v248 offset:17408
    s_waitcnt lgkmcnt(6)
    v_mfma_f32_16x16x32_bf16 v[36:39], v[232:235], v[156:159], v[36:39]
    v_mfma_f32_16x16x32_bf16 v[40:43], v[232:235], v[160:163], v[40:43]
    v_mfma_f32_16x16x32_bf16 v[44:47], v[232:235], v[164:167], v[44:47]
    ds_read_b64_tr_b16 v[232:233], v249 offset:16384
    ds_read_b64_tr_b16 v[234:235], v249 offset:17408
    s_waitcnt lgkmcnt(6)
    v_mfma_f32_16x16x32_bf16 v[48:51], v[220:223], v[156:159], v[48:51]
    v_mfma_f32_16x16x32_bf16 v[52:55], v[220:223], v[160:163], v[52:55]
    v_mfma_f32_16x16x32_bf16 v[56:59], v[220:223], v[164:167], v[56:59]
    ds_read_b64_tr_b16 v[220:221], v242 offset:18432
    ds_read_b64_tr_b16 v[222:223], v242 offset:19456
    s_waitcnt lgkmcnt(6)
    v_mfma_f32_16x16x32_bf16 v[60:63], v[224:227], v[156:159], v[60:63]
    v_mfma_f32_16x16x32_bf16 v[64:67], v[224:227], v[160:163], v[64:67]
    v_mfma_f32_16x16x32_bf16 v[68:71], v[224:227], v[164:167], v[68:71]
    ds_read_b64_tr_b16 v[224:225], v243 offset:18432
    ds_read_b64_tr_b16 v[226:227], v243 offset:19456
    s_waitcnt lgkmcnt(6)
    v_mfma_f32_16x16x32_bf16 v[72:75], v[228:231], v[156:159], v[72:75]
    v_mfma_f32_16x16x32_bf16 v[76:79], v[228:231], v[160:163], v[76:79]
    v_mfma_f32_16x16x32_bf16 v[80:83], v[228:231], v[164:167], v[80:83]
    ds_read_b64_tr_b16 v[228:229], v244 offset:18432
    ds_read_b64_tr_b16 v[230:231], v244 offset:19456
    s_waitcnt lgkmcnt(6)
    v_mfma_f32_16x16x32_bf16 v[84:87], v[232:235], v[156:159], v[84:87]
    v_mfma_f32_16x16x32_bf16 v[88:91], v[232:235], v[160:163], v[88:91]
    v_mfma_f32_16x16x32_bf16 v[92:95], v[232:235], v[164:167], v[92:95]
    ds_read_b64_tr_b16 v[232:233], v245 offset:18432
    ds_read_b64_tr_b16 v[234:235], v245 offset:19456
    s_waitcnt lgkmcnt(6)
    v_mfma_f32_16x16x32_bf16 v[0:3], v[220:223], v[180:183], v[0:3]
    v_mfma_f32_16x16x32_bf16 v[4:7], v[220:223], v[184:187], v[4:7]
    v_mfma_f32_16x16x32_bf16 v[8:11], v[220:223], v[188:191], v[8:11]
    ds_read_b64_tr_b16 v[220:221], v246 offset:18432
    ds_read_b64_tr_b16 v[222:223], v246 offset:19456
    s_waitcnt lgkmcnt(6)
    v_mfma_f32_16x16x32_bf16 v[12:15], v[224:227], v[180:183], v[12:15]
    v_mfma_f32_16x16x32_bf16 v[16:19], v[224:227], v[184:187], v[16:19]
    v_mfma_f32_16x16x32_bf16 v[20:23], v[224:227], v[188:191], v[20:23]
    ds_read_b64_tr_b16 v[224:225], v247 offset:18432
    ds_read_b64_tr_b16 v[226:227], v247 offset:19456
    s_waitcnt lgkmcnt(6)
    v_mfma_f32_16x16x32_bf16 v[24:27], v[228:231], v[180:183], v[24:27]
    v_mfma_f32_16x16x32_bf16 v[28:31], v[228:231], v[184:187], v[28:31]
    v_mfma_f32_16x16x32_bf16 v[32:35], v[228:231], v[188:191], v[32:35]
    ds_read_b64_tr_b16 v[228:229], v248 offset:18432
    ds_read_b64_tr_b16 v[230:231], v248 offset:19456
    s_waitcnt lgkmcnt(6)
    v_mfma_f32_16x16x32_bf16 v[36:39], v[232:235], v[180:183], v[36:39]
    v_mfma_f32_16x16x32_bf16 v[40:43], v[232:235], v[184:187], v[40:43]
    v_mfma_f32_16x16x32_bf16 v[44:47], v[232:235], v[188:191], v[44:47]
    ds_read_b64_tr_b16 v[232:233], v249 offset:18432
    ds_read_b64_tr_b16 v[234:235], v249 offset:19456
    s_waitcnt lgkmcnt(6)
    v_mfma_f32_16x16x32_bf16 v[48:51], v[220:223], v[180:183], v[48:51]
    v_mfma_f32_16x16x32_bf16 v[52:55], v[220:223], v[184:187], v[52:55]
    v_mfma_f32_16x16x32_bf16 v[56:59], v[220:223], v[188:191], v[56:59]
    s_waitcnt lgkmcnt(4)
    v_mfma_f32_16x16x32_bf16 v[60:63], v[224:227], v[180:183], v[60:63]
    v_mfma_f32_16x16x32_bf16 v[64:67], v[224:227], v[184:187], v[64:67]
    v_mfma_f32_16x16x32_bf16 v[68:71], v[224:227], v[188:191], v[68:71]
    s_waitcnt lgkmcnt(2)
    v_mfma_f32_16x16x32_bf16 v[72:75], v[228:231], v[180:183], v[72:75]
    v_mfma_f32_16x16x32_bf16 v[76:79], v[228:231], v[184:187], v[76:79]
    v_mfma_f32_16x16x32_bf16 v[80:83], v[228:231], v[188:191], v[80:83]
    s_waitcnt lgkmcnt(0)
    v_mfma_f32_16x16x32_bf16 v[84:87], v[232:235], v[180:183], v[84:87]
    v_mfma_f32_16x16x32_bf16 v[88:91], v[232:235], v[184:187], v[88:91]
    v_mfma_f32_16x16x32_bf16 v[92:95], v[232:235], v[188:191], v[92:95]
    s_add_u32 s24, s24, 1
    s_add_u32 s22, s22, 16384
    s_add_u32 s31, s31, 1
    s_cmp_eq_u32 s31, s32
    s_cbranch_scc1 L_pp_13
L_pb_14:
    s_add_u32 m0, s21, 16384
    s_waitcnt vmcnt(4)
    s_barrier
    ds_read_b128 v[220:223], v238
    ds_read_b128 v[224:227], v239
    ds_read_b128 v[228:231], v240
    ds_read_b128 v[232:235], v241
    buffer_load_dwordx4 v236, s[8:11], s22 offen nt lds
    buffer_load_dwordx4 v236, s[8:11], s22 offen offset:1024 nt lds
    buffer_load_dwordx4 v236, s[8:11], s22 offen offset:2048 nt lds
    buffer_load_dwordx4 v236, s[8:11], s22 offen offset:3072 nt lds
    s_waitcnt lgkmcnt(3)
    v_mfma_f32_16x16x32_bf16 v[156:159], v[220:223], v[108:111], v[208:211]
    v_mfma_f32_16x16x32_bf16 v[160:163], v[220:223], v[124:127], v[212:215]
    v_mfma_f32_16x16x32_bf16 v[164:167], v[220:223], v[140:143], v[216:219]
    ds_read_b128 v[220:223], v238 offset:1024
    s_waitcnt lgkmcnt(3)
    v_mfma_f32_16x16x32_bf16 v[156:159], v[224:227], v[112:115], v[156:159]
    v_mfma_f32_16x16x32_bf16 v[160:163], v[224:227], v[128:131], v[160:163]
    v_mfma_f32_16x16x32_bf16 v[164:167], v[224:227], v[144:147], v[164:167]
    ds_read_b128 v[224:227], v239 offset:1024
    s_waitcnt lgkmcnt(3)
    v_mfma_f32_16x16x32_bf16 v[156:159], v[228:231], v[116:119], v[156:159]
    v_mfma_f32_16x16x32_bf16 v[160:163], v[228:231], v[132:135], v[160:163]
    v_mfma_f32_16x16x32_bf16 v[164:167], v[228:231], v[148:151], v[164:167]
    ds_read_b128 v[228:231], v240 offset:1024
    s_waitcnt lgkmcnt(3)
    v_mfma_f32_16x16x32_bf16 v[156:159], v[232:235], v[120:123], v[156:159]
    v_mfma_f32_16x16x32_bf16 v[160:163], v[232:235], v[136:139], v[160:163]
    v_mfma_f32_16x16x32_bf16 v[164:167], v[232:235], v[152:155], v[164:167]
    ds_read_b128 v[232:235], v241 offset:1024
    s_waitcnt lgkmcnt(3)
    v_mfma_f32_16x16x32_bf16 v[168:171], v[220:223], v[108:111], v[208:211]
    v_mfma_f32_16x16x32_bf16 v[172:175], v[220:223], v[124:127], v[212:215]
    v_mfma_f32_16x16x32_bf16 v[176:179], v[220:223], v[140:143], v[216:219]
    ds_read_b128 v[220:223], v238 offset:2048
    s_waitcnt lgkmcnt(3)
    v_mfma_f32_16x16x32_bf16 v[168:171], v[224:227], v[112:115], v[168:171]
    v_mfma_f32_16x16x32_bf16 v[172:175], v[224:227], v[128:131], v[172:175]
    v_mfma_f32_16x16x32_bf16 v[176:179], v[224:227], v[144:147], v[176:179]
    ds_read_b128 v[224:227], v239 offset:2048
    s_waitcnt lgkmcnt(3)
    v_mfma_f32_16x16x32_bf16 v[168:171], v[228:231], v[116:119], v[168:171]
    v_mfma_f32_16x16x32_bf16 v[172:175], v[228:231], v[132:135], v[172:175]
    v_mfma_f32_16x16x32_bf16 v[176:179], v[228:231], v[148:151], v[176:179]
    ds_read_b128 v[228:231], v240 offset:2048
    s_waitcnt lgkmcnt(3)
    v_mfma_f32_16x16x32_bf16 v[168:171], v[232:235], v[120:123], v[168:171]
    v_mfma_f32_16x16x32_bf16 v[172:175], v[232:235], v[136:139], v[172:175]
    v_mfma_f32_16x16x32_bf16 v[176:179], v[232:235], v[152:155], v[176:179]
    ds_read_b128 v[232:235], v241 offset:2048
    s_waitcnt lgkmcnt(3)
    v_mfma_f32_16x16x32_bf16 v[180:183], v[220:223], v[108:111], v[208:211]
    v_mfma_f32_16x16x32_bf16 v[184:187], v[220:223], v[124:127], v[212:215]
    v_mfma_f32_16x16x32_bf16 v[188:191], v[220:223], v[140:143], v[216:219]
    ds_read_b128 v[220:223], v238 offset:3072
    s_waitcnt lgkmcnt(3)
    v_mfma_f32_16x16x32_bf16 v[180:183], v[224:227], v[112:115], v[180:183]
    v_mfma_f32_16x16x32_bf16 v[184:187], v[224:227], v[128:131], v[184:187]
    v_mfma_f32_16x16x32_bf16 v[188:191], v[224:227], v[144:147], v[188:191]
    ds_read_b128 v[224:227], v239 offset:3072
    s_waitcnt lgkmcnt(3)
    v_mfma_f32_16x16x32_bf16 v[180:183], v[228:231], v[116:119], v[180:183]
    v_mfma_f32_16x16x32_bf16 v[184:187], v[228:231], v[132:135], v[184:187]
    v_mfma_f32_16x16x32_bf16 v[188:191], v[228:231], v[148:151], v[188:191]
    ds_read_b128 v[228:231], v240 offset:3072
    s_waitcnt lgkmcnt(3)
    v_mfma_f32_16x16x32_bf16 v[180:183], v[232:235], v[120:123], v[180:183]
    v_mfma_f32_16x16x32_bf16 v[184:187], v[232:235], v[136:139], v[184:187]
    v_mfma_f32_16x16x32_bf16 v[188:191], v[232:235], v[152:155], v[188:191]
    ds_read_b128 v[232:235], v241 offset:3072
    s_waitcnt lgkmcnt(3)
    v_mfma_f32_16x16x32_bf16 v[192:195], v[220:223], v[108:111], v[208:211]
    v_mfma_f32_16x16x32_bf16 v[196:199], v[220:223], v[124:127], v[212:215]
    v_mfma_f32_16x16x32_bf16 v[200:203], v[220:223], v[140:143], v[216:219]
    s_waitcnt lgkmcnt(2)
    v_mfma_f32_16x16x32_bf16 v[192:195], v[224:227], v[112:115], v[192:195]
    v_mfma_f32_16x16x32_bf16 v[196:199], v[224:227], v[128:131], v[196:199]
    v_mfma_f32_16x16x32_bf16 v[200:203], v[224:227], v[144:147], v[200:203]
    s_waitcnt lgkmcnt(1)
    v_mfma_f32_16x16x32_bf16 v[192:195], v[228:231], v[116:119], v[192:195]
    v_mfma_f32_16x16x32_bf16 v[196:199], v[228:231], v[132:135], v[196:199]
    v_mfma_f32_16x16x32_bf16 v[200:203], v[228:231], v[148:151], v[200:203]
    s_waitcnt lgkmcnt(0)
    v_mfma_f32_16x16x32_bf16 v[192:195], v[232:235], v[120:123], v[192:195]
    v_mfma_f32_16x16x32_bf16 v[196:199], v[232:235], v[136:139], v[196:199]
    v_mfma_f32_16x16x32_bf16 v[200:203], v[232:235], v[152:155], v[200:203]
    v_exp_f32 v156, v156
    v_exp_f32 v157, v157
    v_exp_f32 v158, v158
    v_exp_f32 v159, v159
    v_exp_f32 v168, v168
    v_exp_f32 v169, v169
    v_exp_f32 v170, v170
    v_exp_f32 v171, v171
    v_exp_f32 v160, v160
    v_exp_f32 v161, v161
    v_exp_f32 v162, v162
    v_exp_f32 v163, v163
    v_cvt_pk_bf16_f32 v156, v156, v157
    v_cvt_pk_bf16_f32 v157, v158, v159
    v_exp_f32 v172, v172
    v_exp_f32 v173, v173
    v_exp_f32 v174, v174
    v_exp_f32 v175, v175
    v_cvt_pk_bf16_f32 v158, v168, v169
    v_cvt_pk_bf16_f32 v159, v170, v171
    v_exp_f32 v164, v164
    v_exp_f32 v165, v165
    v_exp_f32 v166, v166
    v_exp_f32 v167, v167
    v_cvt_pk_bf16_f32 v160, v160, v161
    v_cvt_pk_bf16_f32 v161, v162, v163
    v_exp_f32 v176, v176
    v_exp_f32 v177, v177
    v_exp_f32 v178, v178
    v_exp_f32 v179, v179
    v_cvt_pk_bf16_f32 v162, v172, v173
    v_cvt_pk_bf16_f32 v163, v174, v175
    v_cvt_pk_bf16_f32 v164, v164, v165
    v_cvt_pk_bf16_f32 v165, v166, v167
    v_cvt_pk_bf16_f32 v166, v176, v177
    v_cvt_pk_bf16_f32 v167, v178, v179
    v_mfma_f32_16x16x32_bf16 v[96:99], v[204:207], v[156:159], 0
    v_mfma_f32_16x16x32_bf16 v[100:103], v[204:207], v[160:163], 0
    v_mfma_f32_16x16x32_bf16 v[104:107], v[204:207], v[164:167], 0
    v_exp_f32 v180, v180
    v_exp_f32 v181, v181
    v_exp_f32 v182, v182
    v_exp_f32 v183, v183
    v_exp_f32 v192, v192
    v_exp_f32 v193, v193
    v_exp_f32 v194, v194
    v_exp_f32 v195, v195
    v_exp_f32 v184, v184
    v_exp_f32 v185, v185
    v_exp_f32 v186, v186
    v_exp_f32 v187, v187
    v_cvt_pk_bf16_f32 v180, v180, v181
    v_cvt_pk_bf16_f32 v181, v182, v183
    v_exp_f32 v196, v196
    v_exp_f32 v197, v197
    v_exp_f32 v198, v198
    v_exp_f32 v199, v199
    v_cvt_pk_bf16_f32 v182, v192, v193
    v_cvt_pk_bf16_f32 v183, v194, v195
    v_exp_f32 v188, v188
    v_exp_f32 v189, v189
    v_exp_f32 v190, v190
    v_exp_f32 v191, v191
    v_cvt_pk_bf16_f32 v184, v184, v185
    v_cvt_pk_bf16_f32 v185, v186, v187
    v_exp_f32 v200, v200
    v_exp_f32 v201, v201
    v_exp_f32 v202, v202
    v_exp_f32 v203, v203
    v_cvt_pk_bf16_f32 v186, v196, v197
    v_cvt_pk_bf16_f32 v187, v198, v199
    v_cvt_pk_bf16_f32 v188, v188, v189
    v_cvt_pk_bf16_f32 v189, v190, v191
    v_cvt_pk_bf16_f32 v190, v200, v201
    v_cvt_pk_bf16_f32 v191, v202, v203
    v_mfma_f32_16x16x32_bf16 v[96:99], v[204:207], v[180:183], v[96:99]
    v_mfma_f32_16x16x32_bf16 v[100:103], v[204:207], v[184:187], v[100:103]
    v_mfma_f32_16x16x32_bf16 v[104:107], v[204:207], v[188:191], v[104:107]
    s_add_u32 m0, s21, 49152
    s_waitcnt vmcnt(4)
    s_barrier
    ds_read_b64_tr_b16 v[220:221], v242
    ds_read_b64_tr_b16 v[222:223], v242 offset:1024
    ds_read_b64_tr_b16 v[224:225], v243
    ds_read_b64_tr_b16 v[226:227], v243 offset:1024
    ds_read_b64_tr_b16 v[228:229], v244
    ds_read_b64_tr_b16 v[230:231], v244 offset:1024
    ds_read_b64_tr_b16 v[232:233], v245
    ds_read_b64_tr_b16 v[234:235], v245 offset:1024
    buffer_load_dwordx4 v237, s[12:15], s22 offen nt lds
    buffer_load_dwordx4 v237, s[12:15], s22 offen offset:1024 nt lds
    buffer_load_dwordx4 v237, s[12:15], s22 offen offset:2048 nt lds
    buffer_load_dwordx4 v237, s[12:15], s22 offen offset:3072 nt lds
    v_max3_f32 v253, v96, v100, v104
    v_cmp_nge_f32 vcc, s35, v253
    s_cbranch_vccnz L_redo0
L_pv0:
    v_add_f32 v250, v250, v96
    v_add_f32 v251, v251, v100
    v_add_f32 v252, v252, v104
    s_waitcnt lgkmcnt(6)
    v_mfma_f32_16x16x32_bf16 v[0:3], v[220:223], v[156:159], v[0:3]
    v_mfma_f32_16x16x32_bf16 v[4:7], v[220:223], v[160:163], v[4:7]
    v_mfma_f32_16x16x32_bf16 v[8:11], v[220:223], v[164:167], v[8:11]
    ds_read_b64_tr_b16 v[220:221], v246
    ds_read_b64_tr_b16 v[222:223], v246 offset:1024
    s_waitcnt lgkmcnt(6)
    v_mfma_f32_16x16x32_bf16 v[12:15], v[224:227], v[156:159], v[12:15]
    v_mfma_f32_16x16x32_bf16 v[16:19], v[224:227], v[160:163], v[16:19]
    v_mfma_f32_16x16x32_bf16 v[20:23], v[224:227], v[164:167], v[20:23]
    ds_read_b64_tr_b16 v[224:225], v247
    ds_read_b64_tr_b16 v[226:227], v247 offset:1024
    s_waitcnt lgkmcnt(6)
    v_mfma_f32_16x16x32_bf16 v[24:27], v[228:231], v[156:159], v[24:27]
    v_mfma_f32_16x16x32_bf16 v[28:31], v[228:231], v[160:163], v[28:31]
    v_mfma_f32_16x16x32_bf16 v[32:35], v[228:231], v[164:167], v[32:35]
    ds_read_b64_tr_b16 v[228:229], v248
    ds_read_b64_tr_b16 v[230:231], v248 offset:1024
    s_waitcnt lgkmcnt(6)
    v_mfma_f32_16x16x32_bf16 v[36:39], v[232:235], v[156:159], v[36:39]
    v_mfma_f32_16x16x32_bf16 v[40:43], v[232:235], v[160:163], v[40:43]
    v_mfma_f32_16x16x32_bf16 v[44:47], v[232:235], v[164:167], v[44:47]
    ds_read_b64_tr_b16 v[232:233], v249
    ds_read_b64_tr_b16 v[234:235], v249 offset:1024
    s_waitcnt lgkmcnt(6)
    v_mfma_f32_16x16x32_bf16 v[48:51], v[220:223], v[156:159], v[48:51]
    v_mfma_f32_16x16x32_bf16 v[52:55], v[220:223], v[160:163], v[52:55]
    v_mfma_f32_16x16x32_bf16 v[56:59], v[220:223], v[164:167], v[56:59]
    ds_read_b64_tr_b16 v[220:221], v242 offset:2048
    ds_read_b64_tr_b16 v[222:223], v242 offset:3072
    s_waitcnt lgkmcnt(6)
    v_mfma_f32_16x16x32_bf16 v[60:63], v[224:227], v[156:159], v[60:63]
    v_mfma_f32_16x16x32_bf16 v[64:67], v[224:227], v[160:163], v[64:67]
    v_mfma_f32_16x16x32_bf16 v[68:71], v[224:227], v[164:167], v[68:71]
    ds_read_b64_tr_b16 v[224:225], v243 offset:2048
    ds_read_b64_tr_b16 v[226:227], v243 offset:3072
    s_waitcnt lgkmcnt(6)
    v_mfma_f32_16x16x32_bf16 v[72:75], v[228:231], v[156:159], v[72:75]
    v_mfma_f32_16x16x32_bf16 v[76:79], v[228:231], v[160:163], v[76:79]
    v_mfma_f32_16x16x32_bf16 v[80:83], v[228:231], v[164:167], v[80:83]
    ds_read_b64_tr_b16 v[228:229], v244 offset:2048
    ds_read_b64_tr_b16 v[230:231], v244 offset:3072
    s_waitcnt lgkmcnt(6)
    v_mfma_f32_16x16x32_bf16 v[84:87], v[232:235], v[156:159], v[84:87]
    v_mfma_f32_16x16x32_bf16 v[88:91], v[232:235], v[160:163], v[88:91]
    v_mfma_f32_16x16x32_bf16 v[92:95], v[232:235], v[164:167], v[92:95]
    ds_read_b64_tr_b16 v[232:233], v245 offset:2048
    ds_read_b64_tr_b16 v[234:235], v245 offset:3072
    s_waitcnt lgkmcnt(6)
    v_mfma_f32_16x16x32_bf16 v[0:3], v[220:223], v[180:183], v[0:3]
    v_mfma_f32_16x16x32_bf16 v[4:7], v[220:223], v[184:187], v[4:7]
    v_mfma_f32_16x16x32_bf16 v[8:11], v[220:223], v[188:191], v[8:11]
    ds_read_b64_tr_b16 v[220:221], v246 offset:2048
    ds_read_b64_tr_b16 v[222:223], v246 offset:3072
    s_waitcnt lgkmcnt(6)
    v_mfma_f32_16x16x32_bf16 v[12:15], v[224:227], v[180:183], v[12:15]
    v_mfma_f32_16x16x32_bf16 v[16:19], v[224:227], v[184:187], v[16:19]
    v_mfma_f32_16x16x32_bf16 v[20:23], v[224:227], v[188:191], v[20:23]
    ds_read_b64_tr_b16 v[224:225], v247 offset:2048
    ds_read_b64_tr_b16 v[226:227], v247 offset:3072
    s_waitcnt lgkmcnt(6)
    v_mfma_f32_16x16x32_bf16 v[24:27], v[228:231], v[180:183], v[24:27]
    v_mfma_f32_16x16x32_bf16 v[28:31], v[228:231], v[184:187], v[28:31]
    v_mfma_f32_16x16x32_bf16 v[32:35], v[228:231], v[188:191], v[32:35]
    ds_read_b64_tr_b16 v[228:229], v248 offset:2048
    ds_read_b64_tr_b16 v[230:231], v248 offset:3072
    s_waitcnt lgkmcnt(6)
    v_mfma_f32_16x16x32_bf16 v[36:39], v[232:235], v[180:183], v[36:39]
    v_mfma_f32_16x16x32_bf16 v[40:43], v[232:235], v[184:187], v[40:43]
    v_mfma_f32_16x16x32_bf16 v[44:47], v[232:235], v[188:191], v[44:47]
    ds_read_b64_tr_b16 v[232:233], v249 offset:2048
    ds_read_b64_tr_b16 v[234:235], v249 offset:3072
    s_waitcnt lgkmcnt(6)
    v_mfma_f32_16x16x32_bf16 v[48:51], v[220:223], v[180:183], v[48:51]
    v_mfma_f32_16x16x32_bf16 v[52:55], v[220:223], v[184:187], v[52:55]
    v_mfma_f32_16x16x32_bf16 v[56:59], v[220:223], v[188:191], v[56:59]
    s_waitcnt lgkmcnt(4)
    v_mfma_f32_16x16x32_bf16 v[60:63], v[224:227], v[180:183], v[60:63]
    v_mfma_f32_16x16x32_bf16 v[64:67], v[224:227], v[184:187], v[64:67]
    v_mfma_f32_16x16x32_bf16 v[68:71], v[224:227], v[188:191], v[68:71]
    s_waitcnt lgkmcnt(2)
    v_mfma_f32_16x16x32_bf16 v[72:75], v[228:231], v[180:183], v[72:75]
    v_mfma_f32_16x16x32_bf16 v[76:79], v[228:231], v[184:187], v[76:79]
    v_mfma_f32_16x16x32_bf16 v[80:83], v[228:231], v[188:191], v[80:83]
    s_waitcnt lgkmcnt(0)
    v_mfma_f32_16x16x32_bf16 v[84:87], v[232:235], v[180:183], v[84:87]
    v_mfma_f32_16x16x32_bf16 v[88:91], v[232:235], v[184:187], v[88:91]
    v_mfma_f32_16x16x32_bf16 v[92:95], v[232:235], v[188:191], v[92:95]
    s_add_u32 s24, s24, 1
    s_add_u32 s22, s22, 16384
    s_add_u32 s31, s31, 1
    s_cmp_eq_u32 s31, s32
    s_cbranch_scc1 L_pp_17
L_pb_18:
    s_branch L_loop
L_vlast:
    v_rcp_f32 v208, v250
    v_rcp_f32 v212, v251
    v_rcp_f32 v216, v252
    s_waitcnt lgkmcnt(6)
    v_mfma_f32_16x16x32_bf16 v[0:3], v[220:223], v[156:159], v[0:3]
    v_mfma_f32_16x16x32_bf16 v[4:7], v[220:223], v[160:163], v[4:7]
    v_mfma_f32_16x16x32_bf16 v[8:11], v[220:223], v[164:167], v[8:11]
    ds_read_b64_tr_b16 v[220:221], v246 offset:16384
    ds_read_b64_tr_b16 v[222:223], v246 offset:17408
    s_waitcnt lgkmcnt(6)
    v_mfma_f32_16x16x32_bf16 v[12:15], v[224:227], v[156:159], v[12:15]
    v_mfma_f32_16x16x32_bf16 v[16:19], v[224:227], v[160:163], v[16:19]
    v_mfma_f32_16x16x32_bf16 v[20:23], v[224:227], v[164:167], v[20:23]
    ds_read_b64_tr_b16 v[224:225], v247 offset:16384
    ds_read_b64_tr_b16 v[226:227], v247 offset:17408
    s_waitcnt lgkmcnt(6)
    v_mfma_f32_16x16x32_bf16 v[24:27], v[228:231], v[156:159], v[24:27]
    v_mfma_f32_16x16x32_bf16 v[28:31], v[228:231], v[160:163], v[28:31]
    v_mfma_f32_16x16x32_bf16 v[32:35], v[228:231], v[164:167], v[32:35]
    ds_read_b64_tr_b16 v[228:229], v248 offset:16384
    ds_read_b64_tr_b16 v[230:231], v248 offset:17408
    s_waitcnt lgkmcnt(6)
    v_mfma_f32_16x16x32_bf16 v[36:39], v[232:235], v[156:159], v[36:39]
    v_mfma_f32_16x16x32_bf16 v[40:43], v[232:235], v[160:163], v[40:43]
    v_mfma_f32_16x16x32_bf16 v[44:47], v[232:235], v[164:167], v[44:47]
    ds_read_b64_tr_b16 v[232:233], v249 offset:16384
    ds_read_b64_tr_b16 v[234:235], v249 offset:17408
    s_waitcnt lgkmcnt(6)
    v_mfma_f32_16x16x32_bf16 v[48:51], v[220:223], v[156:159], v[48:51]
    v_mfma_f32_16x16x32_bf16 v[52:55], v[220:223], v[160:163], v[52:55]
    v_mfma_f32_16x16x32_bf16 v[56:59], v[220:223], v[164:167], v[56:59]
    ds_read_b64_tr_b16 v[220:221], v242 offset:18432
    ds_read_b64_tr_b16 v[222:223], v242 offset:19456
    s_waitcnt lgkmcnt(6)
    v_mfma_f32_16x16x32_bf16 v[60:63], v[224:227], v[156:159], v[60:63]
    v_mfma_f32_16x16x32_bf16 v[64:67], v[224:227], v[160:163], v[64:67]
    v_mfma_f32_16x16x32_bf16 v[68:71], v[224:227], v[164:167], v[68:71]
    ds_read_b64_tr_b16 v[224:225], v243 offset:18432
    ds_read_b64_tr_b16 v[226:227], v243 offset:19456
    s_waitcnt lgkmcnt(6)
    v_mfma_f32_16x16x32_bf16 v[72:75], v[228:231], v[156:159], v[72:75]
    v_mfma_f32_16x16x32_bf16 v[76:79], v[228:231], v[160:163], v[76:79]
    v_mfma_f32_16x16x32_bf16 v[80:83], v[228:231], v[164:167], v[80:83]
    ds_read_b64_tr_b16 v[228:229], v244 offset:18432
    ds_read_b64_tr_b16 v[230:231], v244 offset:19456
    s_waitcnt lgkmcnt(6)
    v_mfma_f32_16x16x32_bf16 v[84:87], v[232:235], v[156:159], v[84:87]
    v_mfma_f32_16x16x32_bf16 v[88:91], v[232:235], v[160:163], v[88:91]
    v_mfma_f32_16x16x32_bf16 v[92:95], v[232:235], v[164:167], v[92:95]
    ds_read_b64_tr_b16 v[232:233], v245 offset:18432
    ds_read_b64_tr_b16 v[234:235], v245 offset:19456
    s_waitcnt lgkmcnt(6)
    v_mfma_f32_16x16x32_bf16 v[0:3], v[220:223], v[180:183], v[0:3]
    v_mfma_f32_16x16x32_bf16 v[4:7], v[220:223], v[184:187], v[4:7]
    v_mfma_f32_16x16x32_bf16 v[8:11], v[220:223], v[188:191], v[8:11]
    ds_read_b64_tr_b16 v[220:221], v246 offset:18432
    ds_read_b64_tr_b16 v[222:223], v246 offset:19456
    s_waitcnt lgkmcnt(6)
    v_mfma_f32_16x16x32_bf16 v[12:15], v[224:227], v[180:183], v[12:15]
    v_mfma_f32_16x16x32_bf16 v[16:19], v[224:227], v[184:187], v[16:19]
    s_nop 0
    v_mul_f32 v0, v0, v208
    v_mul_f32 v1, v1, v208
    v_mul_f32 v2, v2, v208
    v_mul_f32 v3, v3, v208
    v_cvt_pk_bf16_f32 v0, v0, v1
    v_cvt_pk_bf16_f32 v1, v2, v3
    v_mul_f32 v4, v4, v212
    v_mul_f32 v5, v5, v212
    v_mfma_f32_16x16x32_bf16 v[20:23], v[224:227], v[188:191], v[20:23]
    v_mul_f32 v6, v6, v212
    v_mul_f32 v7, v7, v212
    v_cvt_pk_bf16_f32 v4, v4, v5
    v_cvt_pk_bf16_f32 v5, v6, v7
    ds_read_b64_tr_b16 v[224:225], v247 offset:18432
    ds_read_b64_tr_b16 v[226:227], v247 offset:19456
    s_waitcnt lgkmcnt(6)
    v_mfma_f32_16x16x32_bf16 v[24:27], v[228:231], v[180:183], v[24:27]
    v_mul_f32 v8, v8, v216
    v_mul_f32 v9, v9, v216
    v_mul_f32 v10, v10, v216
    v_mul_f32 v11, v11, v216
    v_mfma_f32_16x16x32_bf16 v[28:31], v[228:231], v[184:187], v[28:31]
    v_cvt_pk_bf16_f32 v8, v8, v9
    v_cvt_pk_bf16_f32 v9, v10, v11
    v_mul_f32 v12, v12, v208
    v_mul_f32 v13, v13, v208
    v_mfma_f32_16x16x32_bf16 v[32:35], v[228:231], v[188:191], v[32:35]
    v_mul_f32 v14, v14, v208
    v_mul_f32 v15, v15, v208
    v_cvt_pk_bf16_f32 v12, v12, v13
    v_cvt_pk_bf16_f32 v13, v14, v15
    ds_read_b64_tr_b16 v[228:229], v248 offset:18432
    ds_read_b64_tr_b16 v[230:231], v248 offset:19456
    s_waitcnt lgkmcnt(6)
    v_mfma_f32_16x16x32_bf16 v[36:39], v[232:235], v[180:183], v[36:39]
    v_mul_f32 v16, v16, v212
    v_mul_f32 v17, v17, v212
    v_mul_f32 v18, v18, v212
    v_mul_f32 v19, v19, v212
    v_mfma_f32_16x16x32_bf16 v[40:43], v[232:235], v[184:187], v[40:43]
    v_cvt_pk_bf16_f32 v16, v16, v17
    v_cvt_pk_bf16_f32 v17, v18, v19
    v_mul_f32 v20, v20, v216
    v_mul_f32 v21, v21, v216
    v_mfma_f32_16x16x32_bf16 v[44:47], v[232:235], v[188:191], v[44:47]
    v_mul_f32 v22, v22, v216
    v_mul_f32 v23, v23, v216
    v_cvt_pk_bf16_f32 v20, v20, v21
    v_cvt_pk_bf16_f32 v21, v22, v23
    ds_read_b64_tr_b16 v[232:233], v249 offset:18432
    ds_read_b64_tr_b16 v[234:235], v249 offset:19456
    s_waitcnt lgkmcnt(6)
    v_mfma_f32_16x16x32_bf16 v[48:51], v[220:223], v[180:183], v[48:51]
    v_mul_f32 v24, v24, v208
    v_mul_f32 v25, v25, v208
    v_mul_f32 v26, v26, v208
    v_mul_f32 v27, v27, v208
    v_mfma_f32_16x16x32_bf16 v[52:55], v[220:223], v[184:187], v[52:55]
    v_cvt_pk_bf16_f32 v24, v24, v25
    v_cvt_pk_bf16_f32 v25, v26, v27
    v_mul_f32 v28, v28, v212
    v_mul_f32 v29, v29, v212
    v_mfma_f32_16x16x32_bf16 v[56:59], v[220:223], v[188:191], v[56:59]
    v_mul_f32 v30, v30, v212
    v_mul_f32 v31, v31, v212
    v_cvt_pk_bf16_f32 v28, v28, v29
    v_cvt_pk_bf16_f32 v29, v30, v31
    s_waitcnt lgkmcnt(4)
    v_mfma_f32_16x16x32_bf16 v[60:63], v[224:227], v[180:183], v[60:63]
    v_mul_f32 v32, v32, v216
    v_mul_f32 v33, v33, v216
    v_mul_f32 v34, v34, v216
    v_mul_f32 v35, v35, v216
    v_mfma_f32_16x16x32_bf16 v[64:67], v[224:227], v[184:187], v[64:67]
    v_cvt_pk_bf16_f32 v32, v32, v33
    v_cvt_pk_bf16_f32 v33, v34, v35
    v_mul_f32 v36, v36, v208
    v_mul_f32 v37, v37, v208
    v_mfma_f32_16x16x32_bf16 v[68:71], v[224:227], v[188:191], v[68:71]
    v_mul_f32 v38, v38, v208
    v_mul_f32 v39, v39, v208
    v_cvt_pk_bf16_f32 v36, v36, v37
    v_cvt_pk_bf16_f32 v37, v38, v39
    s_waitcnt lgkmcnt(2)
    v_mfma_f32_16x16x32_bf16 v[72:75], v[228:231], v[180:183], v[72:75]
    v_mul_f32 v40, v40, v212
    v_mul_f32 v41, v41, v212
    v_mul_f32 v42, v42, v212
    v_mul_f32 v43, v43, v212
    v_mfma_f32_16x16x32_bf16 v[76:79], v[228:231], v[184:187], v[76:79]
    v_cvt_pk_bf16_f32 v40, v40, v41
    v_cvt_pk_bf16_f32 v41, v42, v43
    v_mul_f32 v44, v44, v216
    v_mul_f32 v45, v45, v216
    v_mfma_f32_16x16x32_bf16 v[80:83], v[228:231], v[188:191], v[80:83]
    v_mul_f32 v46, v46, v216
    v_mul_f32 v47, v47, v216
    v_cvt_pk_bf16_f32 v44, v44, v45
    v_cvt_pk_bf16_f32 v45, v46, v47
    s_waitcnt lgkmcnt(0)
    v_mfma_f32_16x16x32_bf16 v[84:87], v[232:235], v[180:183], v[84:87]
    v_mul_f32 v48, v48, v208
    v_mul_f32 v49, v49, v208
    v_mul_f32 v50, v50, v208
    v_mul_f32 v51, v51, v208
    v_mfma_f32_16x16x32_bf16 v[88:91], v[232:235], v[184:187], v[88:91]
    v_cvt_pk_bf16_f32 v48, v48, v49
    v_cvt_pk_bf16_f32 v49, v50, v51
    v_mul_f32 v52, v52, v212
    v_mul_f32 v53, v53, v212
    v_mfma_f32_16x16x32_bf16 v[92:95], v[232:235], v[188:191], v[92:95]
    v_mul_f32 v54, v54, v212
    v_mul_f32 v55, v55, v212
    v_cvt_pk_bf16_f32 v52, v52, v53
    v_cvt_pk_bf16_f32 v53, v54, v55
    v_mul_f32 v56, v56, v216
    v_mul_f32 v57, v57, v216
    v_mul_f32 v58, v58, v216
    v_mul_f32 v59, v59, v216
    v_cvt_pk_bf16_f32 v56, v56, v57
    v_cvt_pk_bf16_f32 v57, v58, v59
    v_mul_f32 v60, v60, v208
    v_mul_f32 v61, v61, v208
    v_mul_f32 v62, v62, v208
    v_mul_f32 v63, v63, v208
    v_cvt_pk_bf16_f32 v60, v60, v61
    v_cvt_pk_bf16_f32 v61, v62, v63
    v_mul_f32 v64, v64, v212
    v_mul_f32 v65, v65, v212
    v_mul_f32 v66, v66, v212
    v_mul_f32 v67, v67, v212
    v_cvt_pk_bf16_f32 v64, v64, v65
    v_cvt_pk_bf16_f32 v65, v66, v67
    v_mul_f32 v68, v68, v216
    v_mul_f32 v69, v69, v216
    v_mul_f32 v70, v70, v216
    v_mul_f32 v71, v71, v216
    v_cvt_pk_bf16_f32 v68, v68, v69
    v_cvt_pk_bf16_f32 v69, v70, v71
    v_mul_f32 v72, v72, v208
    v_mul_f32 v73, v73, v208
    v_mul_f32 v74, v74, v208
    v_mul_f32 v75, v75, v208
    v_cvt_pk_bf16_f32 v72, v72, v73
    v_cvt_pk_bf16_f32 v73, v74, v75
    v_mul_f32 v76, v76, v212
    v_mul_f32 v77, v77, v212
    v_mul_f32 v78, v78, v212
    v_mul_f32 v79, v79, v212
    v_cvt_pk_bf16_f32 v76, v76, v77
    v_cvt_pk_bf16_f32 v77, v78, v79
    v_mul_f32 v80, v80, v216
    v_mul_f32 v81, v81, v216
    v_mul_f32 v82, v82, v216
    v_mul_f32 v83, v83, v216
    v_cvt_pk_bf16_f32 v80, v80, v81
    v_cvt_pk_bf16_f32 v81, v82, v83
    v_mul_f32 v84, v84, v208
    v_mul_f32 v85, v85, v208
    v_mul_f32 v86, v86, v208
    v_mul_f32 v87, v87, v208
    v_cvt_pk_bf16_f32 v84, v84, v85
    v_cvt_pk_bf16_f32 v85, v86, v87
    v_mul_f32 v88, v88, v212
    v_mul_f32 v89, v89, v212
    v_mul_f32 v90, v90, v212
    v_mul_f32 v91, v91, v212
    v_cvt_pk_bf16_f32 v88, v88, v89
    v_cvt_pk_bf16_f32 v89, v90, v91
    v_mul_f32 v92, v92, v216
    v_mul_f32 v93, v93, v216
    v_mul_f32 v94, v94, v216
    v_mul_f32 v95, v95, v216
    v_cvt_pk_bf16_f32 v92, v92, v93
    v_cvt_pk_bf16_f32 v93, v94, v95
    s_add_u32 s31, s31, 1
    s_cmp_eq_u32 s31, s32
    s_cbranch_scc1 L_pp_21
L_pb_22:
    s_branch L_head
L_redo0:
    s_waitcnt lgkmcnt(0)
    ds_read_b128 v[220:223], v238
    ds_read_b128 v[224:227], v239
    ds_read_b128 v[228:231], v240
    ds_read_b128 v[232:235], v241
    s_waitcnt lgkmcnt(3)
    v_mfma_f32_16x16x32_bf16 v[156:159], v[220:223], v[108:111], 0
    v_mfma_f32_16x16x32_bf16 v[160:163], v[220:223], v[124:127], 0
    v_mfma_f32_16x16x32_bf16 v[164:167], v[220:223], v[140:143], 0
    ds_read_b128 v[220:223], v238 offset:1024
    s_waitcnt lgkmcnt(3)
    v_mfma_f32_16x16x32_bf16 v[156:159], v[224:227], v[112:115], v[156:159]
    v_mfma_f32_16x16x32_bf16 v[160:163], v[224:227], v[128:131], v[160:163]
    v_mfma_f32_16x16x32_bf16 v[164:167], v[224:227], v[144:147], v[164:167]
    ds_read_b128 v[224:227], v239 offset:1024
    s_waitcnt lgkmcnt(3)
    v_mfma_f32_16x16x32_bf16 v[156:159], v[228:231], v[116:119], v[156:159]
    v_mfma_f32_16x16x32_bf16 v[160:163], v[228:231], v[132:135], v[160:163]
    v_mfma_f32_16x16x32_bf16 v[164:167], v[228:231], v[148:151], v[164:167]
    ds_read_b128 v[228:231], v240 offset:1024
    s_waitcnt lgkmcnt(3)
    v_mfma_f32_16x16x32_bf16 v[156:159], v[232:235], v[120:123], v[156:159]
    v_mfma_f32_16x16x32_bf16 v[160:163], v[232:235], v[136:139], v[160:163]
    v_mfma_f32_16x16x32_bf16 v[164:167], v[232:235], v[152:155], v[164:167]
    ds_read_b128 v[232:235], v241 offset:1024
    s_waitcnt lgkmcnt(3)
    v_mfma_f32_16x16x32_bf16 v[168:171], v[220:223], v[108:111], 0
    v_mfma_f32_16x16x32_bf16 v[172:175], v[220:223], v[124:127], 0
    v_mfma_f32_16x16x32_bf16 v[176:179], v[220:223], v[140:143], 0
    ds_read_b128 v[220:223], v238 offset:2048
    s_waitcnt lgkmcnt(3)
    v_mfma_f32_16x16x32_bf16 v[168:171], v[224:227], v[112:115], v[168:171]
    v_mfma_f32_16x16x32_bf16 v[172:175], v[224:227], v[128:131], v[172:175]
    v_mfma_f32_16x16x32_bf16 v[176:179], v[224:227], v[144:147], v[176:179]
    ds_read_b128 v[224:227], v239 offset:2048
    s_waitcnt lgkmcnt(3)
    v_mfma_f32_16x16x32_bf16 v[168:171], v[228:231], v[116:119], v[168:171]
    v_mfma_f32_16x16x32_bf16 v[172:175], v[228:231], v[132:135], v[172:175]
    v_mfma_f32_16x16x32_bf16 v[176:179], v[228:231], v[148:151], v[176:179]
    ds_read_b128 v[228:231], v240 offset:2048
    s_waitcnt lgkmcnt(3)
    v_mfma_f32_16x16x32_bf16 v[168:171], v[232:235], v[120:123], v[168:171]
    v_mfma_f32_16x16x32_bf16 v[172:175], v[232:235], v[136:139], v[172:175]
    v_mfma_f32_16x16x32_bf16 v[176:179], v[232:235], v[152:155], v[176:179]
    ds_read_b128 v[232:235], v241 offset:2048
    s_waitcnt lgkmcnt(3)
    v_mfma_f32_16x16x32_bf16 v[180:183], v[220:223], v[108:111], 0
    v_mfma_f32_16x16x32_bf16 v[184:187], v[220:223], v[124:127], 0
    v_mfma_f32_16x16x32_bf16 v[188:191], v[220:223], v[140:143], 0
    ds_read_b128 v[220:223], v238 offset:3072
    s_waitcnt lgkmcnt(3)
    v_mfma_f32_16x16x32_bf16 v[180:183], v[224:227], v[112:115], v[180:183]
    v_mfma_f32_16x16x32_bf16 v[184:187], v[224:227], v[128:131], v[184:187]
    v_mfma_f32_16x16x32_bf16 v[188:191], v[224:227], v[144:147], v[188:191]
    ds_read_b128 v[224:227], v239 offset:3072
    s_waitcnt lgkmcnt(3)
    v_mfma_f32_16x16x32_bf16 v[180:183], v[228:231], v[116:119], v[180:183]
    v_mfma_f32_16x16x32_bf16 v[184:187], v[228:231], v[132:135], v[184:187]
    v_mfma_f32_16x16x32_bf16 v[188:191], v[228:231], v[148:151], v[188:191]
    ds_read_b128 v[228:231], v240 offset:3072
    s_waitcnt lgkmcnt(3)
    v_mfma_f32_16x16x32_bf16 v[180:183], v[232:235], v[120:123], v[180:183]
    v_mfma_f32_16x16x32_bf16 v[184:187], v[232:235], v[136:139], v[184:187]
    v_mfma_f32_16x16x32_bf16 v[188:191], v[232:235], v[152:155], v[188:191]
    ds_read_b128 v[232:235], v241 offset:3072
    s_waitcnt lgkmcnt(3)
    v_mfma_f32_16x16x32_bf16 v[192:195], v[220:223], v[108:111], 0
    v_mfma_f32_16x16x32_bf16 v[196:199], v[220:223], v[124:127], 0
    v_mfma_f32_16x16x32_bf16 v[200:203], v[220:223], v[140:143], 0
    s_waitcnt lgkmcnt(2)
    v_mfma_f32_16x16x32_bf16 v[192:195], v[224:227], v[112:115], v[192:195]
    v_mfma_f32_16x16x32_bf16 v[196:199], v[224:227], v[128:131], v[196:199]
    v_mfma_f32_16x16x32_bf16 v[200:203], v[224:227], v[144:147], v[200:203]
    s_waitcnt lgkmcnt(1)
    v_mfma_f32_16x16x32_bf16 v[192:195], v[228:231], v[116:119], v[192:195]
    v_mfma_f32_16x16x32_bf16 v[196:199], v[228:231], v[132:135], v[196:199]
    v_mfma_f32_16x16x32_bf16 v[200:203], v[228:231], v[148:151], v[200:203]
    s_waitcnt lgkmcnt(0)
    v_mfma_f32_16x16x32_bf16 v[192:195], v[232:235], v[120:123], v[192:195]
    v_mfma_f32_16x16x32_bf16 v[196:199], v[232:235], v[136:139], v[196:199]
    v_mfma_f32_16x16x32_bf16 v[200:203], v[232:235], v[152:155], v[200:203]
    ds_read_b64_tr_b16 v[220:221], v242
    ds_read_b64_tr_b16 v[222:223], v242 offset:1024
    ds_read_b64_tr_b16 v[224:225], v243
    ds_read_b64_tr_b16 v[226:227], v243 offset:1024
    ds_read_b64_tr_b16 v[228:229], v244
    ds_read_b64_tr_b16 v[230:231], v244 offset:1024
    ds_read_b64_tr_b16 v[232:233], v245
    ds_read_b64_tr_b16 v[234:235], v245 offset:1024
    v_max3_f32 v209, v156, v157, v158
    v_max3_f32 v213, v160, v161, v162
    v_max3_f32 v217, v164, v165, v166
    v_max3_f32 v209, v209, v159, v168
    v_max3_f32 v213, v213, v163, v172
    v_max3_f32 v217, v217, v167, v176
    v_max3_f32 v209, v209, v169, v170
    v_max3_f32 v213, v213, v173, v174
    v_max3_f32 v217, v217, v177, v178
    v_max3_f32 v209, v209, v171, v180
    v_max3_f32 v213, v213, v175, v184
    v_max3_f32 v217, v217, v179, v188
    v_max3_f32 v209, v209, v181, v182
    v_max3_f32 v213, v213, v185, v186
    v_max3_f32 v217, v217, v189, v190
    v_max3_f32 v209, v209, v183, v192
    v_max3_f32 v213, v213, v187, v196
    v_max3_f32 v217, v217, v191, v200
    v_max3_f32 v209, v209, v193, v194
    v_max3_f32 v213, v213, v197, v198
    v_max3_f32 v217, v217, v201, v202
    v_max_f32 v209, v209, v195
    v_max_f32 v213, v213, v199
    v_max_f32 v217, v217, v203
    v_mov_b32 v210, v209
    v_mov_b32 v214, v213
    v_mov_b32 v218, v217
    s_nop 1
    v_permlane16_swap_b32 v209, v210
    v_permlane16_swap_b32 v213, v214
    v_permlane16_swap_b32 v217, v218
    v_max_f32 v209, v209, v210
    v_max_f32 v213, v213, v214
    v_max_f32 v217, v217, v218
    v_mov_b32 v210, v209
    v_mov_b32 v214, v213
    v_mov_b32 v218, v217
    s_nop 1
    v_permlane32_swap_b32 v209, v210
    v_permlane32_swap_b32 v213, v214
    v_permlane32_swap_b32 v217, v218
    v_max_f32 v209, v209, v210
    v_max_f32 v213, v213, v214
    v_max_f32 v217, v217, v218
    v_sub_f32 v209, 0xc0e00000, v209
    v_sub_f32 v213, 0xc0e00000, v213
    v_sub_f32 v217, 0xc0e00000, v217
    v_min_f32 v209, v209, v208
    v_min_f32 v213, v213, v212
    v_min_f32 v217, v217, v216
    v_sub_f32 v210, v209, v208
    v_sub_f32 v214, v213, v212
    v_sub_f32 v218, v217, v216
    v_exp_f32 v210, v210
    v_exp_f32 v214, v214
    v_exp_f32 v218, v218
    s_nop 0
    v_mul_f32 v250, v250, v210
    v_mul_f32 v251, v251, v214
    v_mul_f32 v252, v252, v218
    v_mul_f32 v0, v0, v210
    v_mul_f32 v1, v1, v210
    v_mul_f32 v2, v2, v210
    v_mul_f32 v3, v3, v210
    v_mul_f32 v4, v4, v214
    v_mul_f32 v5, v5, v214
    v_mul_f32 v6, v6, v214
    v_mul_f32 v7, v7, v214
    v_mul_f32 v8, v8, v218
    v_mul_f32 v9, v9, v218
    v_mul_f32 v10, v10, v218
    v_mul_f32 v11, v11, v218
    v_mul_f32 v12, v12, v210
    v_mul_f32 v13, v13, v210
    v_mul_f32 v14, v14, v210
    v_mul_f32 v15, v15, v210
    v_mul_f32 v16, v16, v214
    v_mul_f32 v17, v17, v214
    v_mul_f32 v18, v18, v214
    v_mul_f32 v19, v19, v214
    v_mul_f32 v20, v20, v218
    v_mul_f32 v21, v21, v218
    v_mul_f32 v22, v22, v218
    v_mul_f32 v23, v23, v218
    v_mul_f32 v24, v24, v210
    v_mul_f32 v25, v25, v210
    v_mul_f32 v26, v26, v210
    v_mul_f32 v27, v27, v210
    v_mul_f32 v28, v28, v214
    v_mul_f32 v29, v29, v214
    v_mul_f32 v30, v30, v214
    v_mul_f32 v31, v31, v214
    v_mul_f32 v32, v32, v218
    v_mul_f32 v33, v33, v218
    v_mul_f32 v34, v34, v218
    v_mul_f32 v35, v35, v218
    v_mul_f32 v36, v36, v210
    v_mul_f32 v37, v37, v210
    v_mul_f32 v38, v38, v210
    v_mul_f32 v39, v39, v210
    v_mul_f32 v40, v40, v214
    v_mul_f32 v41, v41, v214
    v_mul_f32 v42, v42, v214
    v_mul_f32 v43, v43, v214
    v_mul_f32 v44, v44, v218
    v_mul_f32 v45, v45, v218
    v_mul_f32 v46, v46, v218
    v_mul_f32 v47, v47, v218
    v_mul_f32 v48, v48, v210
    v_mul_f32 v49, v49, v210
    v_mul_f32 v50, v50, v210
    v_mul_f32 v51, v51, v210
    v_mul_f32 v52, v52, v214
    v_mul_f32 v53, v53, v214
    v_mul_f32 v54, v54, v214
    v_mul_f32 v55, v55, v214
    v_mul_f32 v56, v56, v218
    v_mul_f32 v57, v57, v218
    v_mul_f32 v58, v58, v218
    v_mul_f32 v59, v59, v218
    v_mul_f32 v60, v60, v210
    v_mul_f32 v61, v61, v210
    v_mul_f32 v62, v62, v210
    v_mul_f32 v63, v63, v210
    v_mul_f32 v64, v64, v214
    v_mul_f32 v65, v65, v214
    v_mul_f32 v66, v66, v214
    v_mul_f32 v67, v67, v214
    v_mul_f32 v68, v68, v218
    v_mul_f32 v69, v69, v218
    v_mul_f32 v70, v70, v218
    v_mul_f32 v71, v71, v218
    v_mul_f32 v72, v72, v210
    v_mul_f32 v73, v73, v210
    v_mul_f32 v74, v74, v210
    v_mul_f32 v75, v75, v210
    v_mul_f32 v76, v76, v214
    v_mul_f32 v77, v77, v214
    v_mul_f32 v78, v78, v214
    v_mul_f32 v79, v79, v214
    v_mul_f32 v80, v80, v218
    v_mul_f32 v81, v81, v218
    v_mul_f32 v82, v82, v218
    v_mul_f32 v83, v83, v218
    v_mul_f32 v84, v84, v210
    v_mul_f32 v85, v85, v210
    v_mul_f32 v86, v86, v210
    v_mul_f32 v87, v87, v210
    v_mul_f32 v88, v88, v214
    v_mul_f32 v89, v89, v214
    v_mul_f32 v90, v90, v214
    v_mul_f32 v91, v91, v214
    v_mul_f32 v92, v92, v218
    v_mul_f32 v93, v93, v218
    v_mul_f32 v94, v94, v218
    v_mul_f32 v95, v95, v218
    v_mov_b32 v208, v209
    v_mov_b32 v210, v209
    v_mov_b32 v211, v209
    v_mov_b32 v212, v213
    v_mov_b32 v214, v213
    v_mov_b32 v215, v213
    v_mov_b32 v216, v217
    v_mov_b32 v218, v217
    v_mov_b32 v219, v217
    v_add_f32 v156, v156, v208
    v_add_f32 v157, v157, v208
    v_add_f32 v158, v158, v208
    v_add_f32 v159, v159, v208
    v_add_f32 v168, v168, v208
    v_add_f32 v169, v169, v208
    v_add_f32 v170, v170, v208
    v_add_f32 v171, v171, v208
    v_add_f32 v180, v180, v208
    v_add_f32 v181, v181, v208
    v_add_f32 v182, v182, v208
    v_add_f32 v183, v183, v208
    v_add_f32 v192, v192, v208
    v_add_f32 v193, v193, v208
    v_add_f32 v194, v194, v208
    v_add_f32 v195, v195, v208
    v_add_f32 v160, v160, v212
    v_add_f32 v161, v161, v212
    v_add_f32 v162, v162, v212
    v_add_f32 v163, v163, v212
    v_add_f32 v172, v172, v212
    v_add_f32 v173, v173, v212
    v_add_f32 v174, v174, v212
    v_add_f32 v175, v175, v212
    v_add_f32 v184, v184, v212
    v_add_f32 v185, v185, v212
    v_add_f32 v186, v186, v212
    v_add_f32 v187, v187, v212
    v_add_f32 v196, v196, v212
    v_add_f32 v197, v197, v212
    v_add_f32 v198, v198, v212
    v_add_f32 v199, v199, v212
    v_add_f32 v164, v164, v216
    v_add_f32 v165, v165, v216
    v_add_f32 v166, v166, v216
    v_add_f32 v167, v167, v216
    v_add_f32 v176, v176, v216
    v_add_f32 v177, v177, v216
    v_add_f32 v178, v178, v216
    v_add_f32 v179, v179, v216
    v_add_f32 v188, v188, v216
    v_add_f32 v189, v189, v216
    v_add_f32 v190, v190, v216
    v_add_f32 v191, v191, v216
    v_add_f32 v200, v200, v216
    v_add_f32 v201, v201, v216
    v_add_f32 v202, v202, v216
    v_add_f32 v203, v203, v216
    v_exp_f32 v156, v156
    v_exp_f32 v157, v157
    v_exp_f32 v158, v158
    v_exp_f32 v159, v159
    v_exp_f32 v168, v168
    v_exp_f32 v169, v169
    v_exp_f32 v170, v170
    v_exp_f32 v171, v171
    v_exp_f32 v160, v160
    v_exp_f32 v161, v161
    v_exp_f32 v162, v162
    v_exp_f32 v163, v163
    v_cvt_pk_bf16_f32 v156, v156, v157
    v_cvt_pk_bf16_f32 v157, v158, v159
    v_exp_f32 v172, v172
    v_exp_f32 v173, v173
    v_exp_f32 v174, v174
    v_exp_f32 v175, v175
    v_cvt_pk_bf16_f32 v158, v168, v169
    v_cvt_pk_bf16_f32 v159, v170, v171
    v_exp_f32 v164, v164
    v_exp_f32 v165, v165
    v_exp_f32 v166, v166
    v_exp_f32 v167, v167
    v_cvt_pk_bf16_f32 v160, v160, v161
    v_cvt_pk_bf16_f32 v161, v162, v163
    v_exp_f32 v176, v176
    v_exp_f32 v177, v177
    v_exp_f32 v178, v178
    v_exp_f32 v179, v179
    v_cvt_pk_bf16_f32 v162, v172, v173
    v_cvt_pk_bf16_f32 v163, v174, v175
    v_cvt_pk_bf16_f32 v164, v164, v165
    v_cvt_pk_bf16_f32 v165, v166, v167
    v_cvt_pk_bf16_f32 v166, v176, v177
    v_cvt_pk_bf16_f32 v167, v178, v179
    v_mfma_f32_16x16x32_bf16 v[96:99], v[204:207], v[156:159], 0
    v_mfma_f32_16x16x32_bf16 v[100:103], v[204:207], v[160:163], 0
    v_mfma_f32_16x16x32_bf16 v[104:107], v[204:207], v[164:167], 0
    v_exp_f32 v180, v180
    v_exp_f32 v181, v181
    v_exp_f32 v182, v182
    v_exp_f32 v183, v183
    v_exp_f32 v192, v192
    v_exp_f32 v193, v193
    v_exp_f32 v194, v194
    v_exp_f32 v195, v195
    v_exp_f32 v184, v184
    v_exp_f32 v185, v185
    v_exp_f32 v186, v186
    v_exp_f32 v187, v187
    v_cvt_pk_bf16_f32 v180, v180, v181
    v_cvt_pk_bf16_f32 v181, v182, v183
    v_exp_f32 v196, v196
    v_exp_f32 v197, v197
    v_exp_f32 v198, v198
    v_exp_f32 v199, v199
    v_cvt_pk_bf16_f32 v182, v192, v193
    v_cvt_pk_bf16_f32 v183, v194, v195
    v_exp_f32 v188, v188
    v_exp_f32 v189, v189
    v_exp_f32 v190, v190
    v_exp_f32 v191, v191
    v_cvt_pk_bf16_f32 v184, v184, v185
    v_cvt_pk_bf16_f32 v185, v186, v187
    v_exp_f32 v200, v200
    v_exp_f32 v201, v201
    v_exp_f32 v202, v202
    v_exp_f32 v203, v203
    v_cvt_pk_bf16_f32 v186, v196, v197
    v_cvt_pk_bf16_f32 v187, v198, v199
    v_cvt_pk_bf16_f32 v188, v188, v189
    v_cvt_pk_bf16_f32 v189, v190, v191
    v_cvt_pk_bf16_f32 v190, v200, v201
    v_cvt_pk_bf16_f32 v191, v202, v203
    v_mfma_f32_16x16x32_bf16 v[96:99], v[204:207], v[180:183], v[96:99]
    v_mfma_f32_16x16x32_bf16 v[100:103], v[204:207], v[184:187], v[100:103]
    v_mfma_f32_16x16x32_bf16 v[104:107], v[204:207], v[188:191], v[104:107]
    s_nop 7
    s_branch L_pv0
L_redo1:
    s_waitcnt lgkmcnt(0)
    ds_read_b128 v[220:223], v238 offset:16384
    ds_read_b128 v[224:227], v239 offset:16384
    ds_read_b128 v[228:231], v240 offset:16384
    ds_read_b128 v[232:235], v241 offset:16384
    s_waitcnt lgkmcnt(3)
    v_mfma_f32_16x16x32_bf16 v[156:159], v[220:223], v[108:111], 0
    v_mfma_f32_16x16x32_bf16 v[160:163], v[220:223], v[124:127], 0
    v_mfma_f32_16x16x32_bf16 v[164:167], v[220:223], v[140:143], 0
    ds_read_b128 v[220:223], v238 offset:17408
    s_waitcnt lgkmcnt(3)
    v_mfma_f32_16x16x32_bf16 v[156:159], v[224:227], v[112:115], v[156:159]
    v_mfma_f32_16x16x32_bf16 v[160:163], v[224:227], v[128:131], v[160:163]
    v_mfma_f32_16x16x32_bf16 v[164:167], v[224:227], v[144:147], v[164:167]
    ds_read_b128 v[224:227], v239 offset:17408
    s_waitcnt lgkmcnt(3)
    v_mfma_f32_16x16x32_bf16 v[156:159], v[228:231], v[116:119], v[156:159]
    v_mfma_f32_16x16x32_bf16 v[160:163], v[228:231], v[132:135], v[160:163]
    v_mfma_f32_16x16x32_bf16 v[164:167], v[228:231], v[148:151], v[164:167]
    ds_read_b128 v[228:231], v240 offset:17408
    s_waitcnt lgkmcnt(3)
    v_mfma_f32_16x16x32_bf16 v[156:159], v[232:235], v[120:123], v[156:159]
    v_mfma_f32_16x16x32_bf16 v[160:163], v[232:235], v[136:139], v[160:163]
    v_mfma_f32_16x16x32_bf16 v[164:167], v[232:235], v[152:155], v[164:167]
    ds_read_b128 v[232:235], v241 offset:17408
    s_waitcnt lgkmcnt(3)
    v_mfma_f32_16x16x32_bf16 v[168:171], v[220:223], v[108:111], 0
    v_mfma_f32_16x16x32_bf16 v[172:175], v[220:223], v[124:127], 0
    v_mfma_f32_16x16x32_bf16 v[176:179], v[220:223], v[140:143], 0
    ds_read_b128 v[220:223], v238 offset:18432
    s_waitcnt lgkmcnt(3)
    v_mfma_f32_16x16x32_bf16 v[168:171], v[224:227], v[112:115], v[168:171]
    v_mfma_f32_16x16x32_bf16 v[172:175], v[224:227], v[128:131], v[172:175]
    v_mfma_f32_16x16x32_bf16 v[176:179], v[224:227], v[144:147], v[176:179]
    ds_read_b128 v[224:227], v239 offset:18432
    s_waitcnt lgkmcnt(3)
    v_mfma_f32_16x16x32_bf16 v[168:171], v[228:231], v[116:119], v[168:171]
    v_mfma_f32_16x16x32_bf16 v[172:175], v[228:231], v[132:135], v[172:175]
    v_mfma_f32_16x16x32_bf16 v[176:179], v[228:231], v[148:151], v[176:179]
    ds_read_b128 v[228:231], v240 offset:18432
    s_waitcnt lgkmcnt(3)
    v_mfma_f32_16x16x32_bf16 v[168:171], v[232:235], v[120:123], v[168:171]
    v_mfma_f32_16x16x32_bf16 v[172:175], v[232:235], v[136:139], v[172:175]
    v_mfma_f32_16x16x32_bf16 v[176:179], v[232:235], v[152:155], v[176:179]
    ds_read_b128 v[232:235], v241 offset:18432
    s_waitcnt lgkmcnt(3)
    v_mfma_f32_16x16x32_bf16 v[180:183], v[220:223], v[108:111], 0
    v_mfma_f32_16x16x32_bf16 v[184:187], v[220:223], v[124:127], 0
    v_mfma_f32_16x16x32_bf16 v[188:191], v[220:223], v[140:143], 0
    ds_read_b128 v[220:223], v238 offset:19456
    s_waitcnt lgkmcnt(3)
    v_mfma_f32_16x16x32_bf16 v[180:183], v[224:227], v[112:115], v[180:183]
    v_mfma_f32_16x16x32_bf16 v[184:187], v[224:227], v[128:131], v[184:187]
    v_mfma_f32_16x16x32_bf16 v[188:191], v[224:227], v[144:147], v[188:191]
    ds_read_b128 v[224:227], v239 offset:19456
    s_waitcnt lgkmcnt(3)
    v_mfma_f32_16x16x32_bf16 v[180:183], v[228:231], v[116:119], v[180:183]
    v_mfma_f32_16x16x32_bf16 v[184:187], v[228:231], v[132:135], v[184:187]
    v_mfma_f32_16x16x32_bf16 v[188:191], v[228:231], v[148:151], v[188:191]
    ds_read_b128 v[228:231], v240 offset:19456
    s_waitcnt lgkmcnt(3)
    v_mfma_f32_16x16x32_bf16 v[180:183], v[232:235], v[120:123], v[180:183]
    v_mfma_f32_16x16x32_bf16 v[184:187], v[232:235], v[136:139], v[184:187]
    v_mfma_f32_16x16x32_bf16 v[188:191], v[232:235], v[152:155], v[188:191]
    ds_read_b128 v[232:235], v241 offset:19456
    s_waitcnt lgkmcnt(3)
    v_mfma_f32_16x16x32_bf16 v[192:195], v[220:223], v[108:111], 0
    v_mfma_f32_16x16x32_bf16 v[196:199], v[220:223], v[124:127], 0
    v_mfma_f32_16x16x32_bf16 v[200:203], v[220:223], v[140:143], 0
    s_waitcnt lgkmcnt(2)
    v_mfma_f32_16x16x32_bf16 v[192:195], v[224:227], v[112:115], v[192:195]
    v_mfma_f32_16x16x32_bf16 v[196:199], v[224:227], v[128:131], v[196:199]
    v_mfma_f32_16x16x32_bf16 v[200:203], v[224:227], v[144:147], v[200:203]
    s_waitcnt lgkmcnt(1)
    v_mfma_f32_16x16x32_bf16 v[192:195], v[228:231], v[116:119], v[192:195]
    v_mfma_f32_16x16x32_bf16 v[196:199], v[228:231], v[132:135], v[196:199]
    v_mfma_f32_16x16x32_bf16 v[200:203], v[228:231], v[148:151], v[200:203]
    s_waitcnt lgkmcnt(0)
    v_mfma_f32_16x16x32_bf16 v[192:195], v[232:235], v[120:123], v[192:195]
    v_mfma_f32_16x16x32_bf16 v[196:199], v[232:235], v[136:139], v[196:199]
    v_mfma_f32_16x16x32_bf16 v[200:203], v[232:235], v[152:155], v[200:203]
    ds_read_b64_tr_b16 v[220:221], v242 offset:16384
    ds_read_b64_tr_b16 v[222:223], v242 offset:17408
    ds_read_b64_tr_b16 v[224:225], v243 offset:16384
    ds_read_b64_tr_b16 v[226:227], v243 offset:17408
    ds_read_b64_tr_b16 v[228:229], v244 offset:16384
    ds_read_b64_tr_b16 v[230:231], v244 offset:17408
    ds_read_b64_tr_b16 v[232:233], v245 offset:16384
    ds_read_b64_tr_b16 v[234:235], v245 offset:17408
    v_max3_f32 v209, v156, v157, v158
    v_max3_f32 v213, v160, v161, v162
    v_max3_f32 v217, v164, v165, v166
    v_max3_f32 v209, v209, v159, v168
    v_max3_f32 v213, v213, v163, v172
    v_max3_f32 v217, v217, v167, v176
    v_max3_f32 v209, v209, v169, v170
    v_max3_f32 v213, v213, v173, v174
    v_max3_f32 v217, v217, v177, v178
    v_max3_f32 v209, v209, v171, v180
    v_max3_f32 v213, v213, v175, v184
    v_max3_f32 v217, v217, v179, v188
    v_max3_f32 v209, v209, v181, v182
    v_max3_f32 v213, v213, v185, v186
    v_max3_f32 v217, v217, v189, v190
    v_max3_f32 v209, v209, v183, v192
    v_max3_f32 v213, v213, v187, v196
    v_max3_f32 v217, v217, v191, v200
    v_max3_f32 v209, v209, v193, v194
    v_max3_f32 v213, v213, v197, v198
    v_max3_f32 v217, v217, v201, v202
    v_max_f32 v209, v209, v195
    v_max_f32 v213, v213, v199
    v_max_f32 v217, v217, v203
    v_mov_b32 v210, v209
    v_mov_b32 v214, v213
    v_mov_b32 v218, v217
    s_nop 1
    v_permlane16_swap_b32 v209, v210
    v_permlane16_swap_b32 v213, v214
    v_permlane16_swap_b32 v217, v218
    v_max_f32 v209, v209, v210
    v_max_f32 v213, v213, v214
    v_max_f32 v217, v217, v218
    v_mov_b32 v210, v209
    v_mov_b32 v214, v213
    v_mov_b32 v218, v217
    s_nop 1
    v_permlane32_swap_b32 v209, v210
    v_permlane32_swap_b32 v213, v214
    v_permlane32_swap_b32 v217, v218
    v_max_f32 v209, v209, v210
    v_max_f32 v213, v213, v214
    v_max_f32 v217, v217, v218
    v_sub_f32 v209, 0xc0e00000, v209
    v_sub_f32 v213, 0xc0e00000, v213
    v_sub_f32 v217, 0xc0e00000, v217
    v_min_f32 v209, v209, v208
    v_min_f32 v213, v213, v212
    v_min_f32 v217, v217, v216
    v_sub_f32 v210, v209, v208
    v_sub_f32 v214, v213, v212
    v_sub_f32 v218, v217, v216
    v_exp_f32 v210, v210
    v_exp_f32 v214, v214
    v_exp_f32 v218, v218
    s_nop 0
    v_mul_f32 v250, v250, v210
    v_mul_f32 v251, v251, v214
    v_mul_f32 v252, v252, v218
    v_mul_f32 v0, v0, v210
    v_mul_f32 v1, v1, v210
    v_mul_f32 v2, v2, v210
    v_mul_f32 v3, v3, v210
    v_mul_f32 v4, v4, v214
    v_mul_f32 v5, v5, v214
    v_mul_f32 v6, v6, v214
    v_mul_f32 v7, v7, v214
    v_mul_f32 v8, v8, v218
    v_mul_f32 v9, v9, v218
    v_mul_f32 v10, v10, v218
    v_mul_f32 v11, v11, v218
    v_mul_f32 v12, v12, v210
    v_mul_f32 v13, v13, v210
    v_mul_f32 v14, v14, v210
    v_mul_f32 v15, v15, v210
    v_mul_f32 v16, v16, v214
    v_mul_f32 v17, v17, v214
    v_mul_f32 v18, v18, v214
    v_mul_f32 v19, v19, v214
    v_mul_f32 v20, v20, v218
    v_mul_f32 v21, v21, v218
    v_mul_f32 v22, v22, v218
    v_mul_f32 v23, v23, v218
    v_mul_f32 v24, v24, v210
    v_mul_f32 v25, v25, v210
    v_mul_f32 v26, v26, v210
    v_mul_f32 v27, v27, v210
    v_mul_f32 v28, v28, v214
    v_mul_f32 v29, v29, v214
    v_mul_f32 v30, v30, v214
    v_mul_f32 v31, v31, v214
    v_mul_f32 v32, v32, v218
    v_mul_f32 v33, v33, v218
    v_mul_f32 v34, v34, v218
    v_mul_f32 v35, v35, v218
    v_mul_f32 v36, v36, v210
    v_mul_f32 v37, v37, v210
    v_mul_f32 v38, v38, v210
    v_mul_f32 v39, v39, v210
    v_mul_f32 v40, v40, v214
    v_mul_f32 v41, v41, v214
    v_mul_f32 v42, v42, v214
    v_mul_f32 v43, v43, v214
    v_mul_f32 v44, v44, v218
    v_mul_f32 v45, v45, v218
    v_mul_f32 v46, v46, v218
    v_mul_f32 v47, v47, v218
    v_mul_f32 v48, v48, v210
    v_mul_f32 v49, v49, v210
    v_mul_f32 v50, v50, v210
    v_mul_f32 v51, v51, v210
    v_mul_f32 v52, v52, v214
    v_mul_f32 v53, v53, v214
    v_mul_f32 v54, v54, v214
    v_mul_f32 v55, v55, v214
    v_mul_f32 v56, v56, v218
    v_mul_f32 v57, v57, v218
    v_mul_f32 v58, v58, v218
    v_mul_f32 v59, v59, v218
    v_mul_f32 v60, v60, v210
    v_mul_f32 v61, v61, v210
    v_mul_f32 v62, v62, v210
    v_mul_f32 v63, v63, v210
    v_mul_f32 v64, v64, v214
    v_mul_f32 v65, v65, v214
    v_mul_f32 v66, v66, v214
    v_mul_f32 v67, v67, v214
    v_mul_f32 v68, v68, v218
    v_mul_f32 v69, v69, v218
    v_mul_f32 v70, v70, v218
    v_mul_f32 v71, v71, v218
    v_mul_f32 v72, v72, v210
    v_mul_f32 v73, v73, v210
    v_mul_f32 v74, v74, v210
    v_mul_f32 v75, v75, v210
    v_mul_f32 v76, v76, v214
    v_mul_f32 v77, v77, v214
    v_mul_f32 v78, v78, v214
    v_mul_f32 v79, v79, v214
    v_mul_f32 v80, v80, v218
    v_mul_f32 v81, v81, v218
    v_mul_f32 v82, v82, v218
    v_mul_f32 v83, v83, v218
    v_mul_f32 v84, v84, v210
    v_mul_f32 v85, v85, v210
    v_mul_f32 v86, v86, v210
    v_mul_f32 v87, v87, v210
    v_mul_f32 v88, v88, v214
    v_mul_f32 v89, v89, v214
    v_mul_f32 v90, v90, v214
    v_mul_f32 v91, v91, v214
    v_mul_f32 v92, v92, v218
    v_mul_f32 v93, v93, v218
    v_mul_f32 v94, v94, v218
    v_mul_f32 v95, v95, v218
    v_mov_b32 v208, v209
    v_mov_b32 v210, v209
    v_mov_b32 v211, v209
    v_mov_b32 v212, v213
    v_mov_b32 v214, v213
    v_mov_b32 v215, v213
    v_mov_b32 v216, v217
    v_mov_b32 v218, v217
    v_mov_b32 v219, v217
    v_add_f32 v156, v156, v208
    v_add_f32 v157, v157, v208
    v_add_f32 v158, v158, v208
    v_add_f32 v159, v159, v208
    v_add_f32 v168, v168, v208
    v_add_f32 v169, v169, v208
    v_add_f32 v170, v170, v208
    v_add_f32 v171, v171, v208
    v_add_f32 v180, v180, v208
    v_add_f32 v181, v181, v208
    v_add_f32 v182, v182, v208
    v_add_f32 v183, v183, v208
    v_add_f32 v192, v192, v208
    v_add_f32 v193, v193, v208
    v_add_f32 v194, v194, v208
    v_add_f32 v195, v195, v208
    v_add_f32 v160, v160, v212
    v_add_f32 v161, v161, v212
    v_add_f32 v162, v162, v212
    v_add_f32 v163, v163, v212
    v_add_f32 v172, v172, v212
    v_add_f32 v173, v173, v212
    v_add_f32 v174, v174, v212
    v_add_f32 v175, v175, v212
    v_add_f32 v184, v184, v212
    v_add_f32 v185, v185, v212
    v_add_f32 v186, v186, v212
    v_add_f32 v187, v187, v212
    v_add_f32 v196, v196, v212
    v_add_f32 v197, v197, v212
    v_add_f32 v198, v198, v212
    v_add_f32 v199, v199, v212
    v_add_f32 v164, v164, v216
    v_add_f32 v165, v165, v216
    v_add_f32 v166, v166, v216
    v_add_f32 v167, v167, v216
    v_add_f32 v176, v176, v216
    v_add_f32 v177, v177, v216
    v_add_f32 v178, v178, v216
    v_add_f32 v179, v179, v216
    v_add_f32 v188, v188, v216
    v_add_f32 v189, v189, v216
    v_add_f32 v190, v190, v216
    v_add_f32 v191, v191, v216
    v_add_f32 v200, v200, v216
    v_add_f32 v201, v201, v216
    v_add_f32 v202, v202, v216
    v_add_f32 v203, v203, v216
    v_exp_f32 v156, v156
    v_exp_f32 v157, v157
    v_exp_f32 v158, v158
    v_exp_f32 v159, v159
    v_exp_f32 v168, v168
    v_exp_f32 v169, v169
    v_exp_f32 v170, v170
    v_exp_f32 v171, v171
    v_exp_f32 v160, v160
    v_exp_f32 v161, v161
    v_exp_f32 v162, v162
    v_exp_f32 v163, v163
    v_cvt_pk_bf16_f32 v156, v156, v157
    v_cvt_pk_bf16_f32 v157, v158, v159
    v_exp_f32 v172, v172
    v_exp_f32 v173, v173
    v_exp_f32 v174, v174
    v_exp_f32 v175, v175
    v_cvt_pk_bf16_f32 v158, v168, v169
    v_cvt_pk_bf16_f32 v159, v170, v171
    v_exp_f32 v164, v164
    v_exp_f32 v165, v165
    v_exp_f32 v166, v166
    v_exp_f32 v167, v167
    v_cvt_pk_bf16_f32 v160, v160, v161
    v_cvt_pk_bf16_f32 v161, v162, v163
    v_exp_f32 v176, v176
    v_exp_f32 v177, v177
    v_exp_f32 v178, v178
    v_exp_f32 v179, v179
    v_cvt_pk_bf16_f32 v162, v172, v173
    v_cvt_pk_bf16_f32 v163, v174, v175
    v_cvt_pk_bf16_f32 v164, v164, v165
    v_cvt_pk_bf16_f32 v165, v166, v167
    v_cvt_pk_bf16_f32 v166, v176, v177
    v_cvt_pk_bf16_f32 v167, v178, v179
    v_mfma_f32_16x16x32_bf16 v[96:99], v[204:207], v[156:159], 0
    v_mfma_f32_16x16x32_bf16 v[100:103], v[204:207], v[160:163], 0
    v_mfma_f32_16x16x32_bf16 v[104:107], v[204:207], v[164:167], 0
    v_exp_f32 v180, v180
    v_exp_f32 v181, v181
    v_exp_f32 v182, v182
    v_exp_f32 v183, v183
    v_exp_f32 v192, v192
    v_exp_f32 v193, v193
    v_exp_f32 v194, v194
    v_exp_f32 v195, v195
    v_exp_f32 v184, v184
    v_exp_f32 v185, v185
    v_exp_f32 v186, v186
    v_exp_f32 v187, v187
    v_cvt_pk_bf16_f32 v180, v180, v181
    v_cvt_pk_bf16_f32 v181, v182, v183
    v_exp_f32 v196, v196
    v_exp_f32 v197, v197
    v_exp_f32 v198, v198
    v_exp_f32 v199, v199
    v_cvt_pk_bf16_f32 v182, v192, v193
    v_cvt_pk_bf16_f32 v183, v194, v195
    v_exp_f32 v188, v188
    v_exp_f32 v189, v189
    v_exp_f32 v190, v190
    v_exp_f32 v191, v191
    v_cvt_pk_bf16_f32 v184, v184, v185
    v_cvt_pk_bf16_f32 v185, v186, v187
    v_exp_f32 v200, v200
    v_exp_f32 v201, v201
    v_exp_f32 v202, v202
    v_exp_f32 v203, v203
    v_cvt_pk_bf16_f32 v186, v196, v197
    v_cvt_pk_bf16_f32 v187, v198, v199
    v_cvt_pk_bf16_f32 v188, v188, v189
    v_cvt_pk_bf16_f32 v189, v190, v191
    v_cvt_pk_bf16_f32 v190, v200, v201
    v_cvt_pk_bf16_f32 v191, v202, v203
    v_mfma_f32_16x16x32_bf16 v[96:99], v[204:207], v[180:183], v[96:99]
    v_mfma_f32_16x16x32_bf16 v[100:103], v[204:207], v[184:187], v[100:103]
    v_mfma_f32_16x16x32_bf16 v[104:107], v[204:207], v[188:191], v[104:107]
    s_nop 7
    s_branch L_pv1
L_last:
    s_waitcnt vmcnt(0)
    s_add_u32 s34, s21, 65536
    v_lshrrev_b32 v158, 1, v157
    v_xor_b32 v158, v158, v156
    v_lshl_add_u32 v158, v158, 4, v159
    v_and_b32 v161, 1, v157
    v_lshl_add_u32 v162, v161, 3, v158
    v_add_u32 v184, s34, v162
    v_xor_b32 v185, 32, v184
    v_xor_b32 v186, 64, v184
    v_xor_b32 v187, 96, v184
    v_xor_b32 v188, 128, v184
    v_xor_b32 v189, 160, v184
    v_xor_b32 v190, 192, v184
    v_xor_b32 v191, 224, v184
    v_xor_b32 v158, v156, v157
    v_lshlrev_b32 v158, 4, v158
    v_lshl_add_u32 v163, v157, 8, v158
    v_add_u32 v180, s34, v163
    v_xor_b32 v181, 64, v180
    v_xor_b32 v182, 128, v180
    v_xor_b32 v183, 192, v180
    v_lshlrev_b32 v168, 4, v164
    v_add_u32 v168, s21, v168
    ds_write_b64 v184, v[0:1]
    ds_write_b64 v185, v[12:13]
    ds_write_b64 v186, v[24:25]
    ds_write_b64 v187, v[36:37]
    ds_write_b64 v188, v[48:49]
    ds_write_b64 v189, v[60:61]
    ds_write_b64 v190, v[72:73]
    ds_write_b64 v191, v[84:85]
    ds_read_b128 v[220:223], v180 offset:0
    ds_read_b128 v[224:227], v181 offset:1024
    ds_read_b128 v[228:231], v182 offset:2048
    ds_read_b128 v[232:235], v183 offset:3072
    s_add_u32 s33, s29, 0
    s_waitcnt lgkmcnt(3)
    buffer_store_dwordx4 v[220:223], v168, s[16:19], s33 offen offset:0 sc1
    s_waitcnt lgkmcnt(2)
    buffer_store_dwordx4 v[224:227], v168, s[16:19], s33 offen offset:1024 sc1
    s_waitcnt lgkmcnt(1)
    buffer_store_dwordx4 v[228:231], v168, s[16:19], s33 offen offset:2048 sc1
    s_waitcnt lgkmcnt(0)
    buffer_store_dwordx4 v[232:235], v168, s[16:19], s33 offen offset:3072 sc1
    ds_write_b64 v184, v[4:5]
    ds_write_b64 v185, v[16:17]
    ds_write_b64 v186, v[28:29]
    ds_write_b64 v187, v[40:41]
    ds_write_b64 v188, v[52:53]
    ds_write_b64 v189, v[64:65]
    ds_write_b64 v190, v[76:77]
    ds_write_b64 v191, v[88:89]
    ds_read_b128 v[172:175], v180 offset:0
    ds_read_b128 v[176:179], v181 offset:1024
    ds_read_b128 v[192:195], v182 offset:2048
    ds_read_b128 v[196:199], v183 offset:3072
    s_add_u32 s33, s29, 16384
    s_waitcnt lgkmcnt(3)
    buffer_store_dwordx4 v[172:175], v168, s[16:19], s33 offen offset:0 sc1
    s_waitcnt lgkmcnt(2)
    buffer_store_dwordx4 v[176:179], v168, s[16:19], s33 offen offset:1024 sc1
    s_waitcnt lgkmcnt(1)
    buffer_store_dwordx4 v[192:195], v168, s[16:19], s33 offen offset:2048 sc1
    s_waitcnt lgkmcnt(0)
    buffer_store_dwordx4 v[196:199], v168, s[16:19], s33 offen offset:3072 sc1
    ds_write_b64 v184, v[8:9]
    ds_write_b64 v185, v[20:21]
    ds_write_b64 v186, v[32:33]
    ds_write_b64 v187, v[44:45]
    ds_write_b64 v188, v[56:57]
    ds_write_b64 v189, v[68:69]
    ds_write_b64 v190, v[80:81]
    ds_write_b64 v191, v[92:93]
    ds_read_b128 v[220:223], v180 offset:0
    ds_read_b128 v[224:227], v181 offset:1024
    ds_read_b128 v[228:231], v182 offset:2048
    ds_read_b128 v[232:235], v183 offset:3072
    s_add_u32 s33, s29, 32768
    s_waitcnt lgkmcnt(3)
    buffer_store_dwordx4 v[220:223], v168, s[16:19], s33 offen offset:0 sc1
    s_waitcnt lgkmcnt(2)
    buffer_store_dwordx4 v[224:227], v168, s[16:19], s33 offen offset:1024 sc1
    s_waitcnt lgkmcnt(1)
    buffer_store_dwordx4 v[228:231], v168, s[16:19], s33 offen offset:2048 sc1
    s_waitcnt lgkmcnt(0)
    buffer_store_dwordx4 v[232:235], v168, s[16:19], s33 offen offset:3072 sc1
    s_branch L_fin
L_w1_1:
    s_waitcnt vmcnt(4)
    s_branch L_wb_2
L_w1_3:
    s_waitcnt vmcnt(4)
    s_branch L_wb_4
L_pp_5:
    s_cmp_eq_u32 s31, 4
    s_cbranch_scc1 L_pa_7
    s_cmp_eq_u32 s31, 8
    s_cbranch_scc1 L_pa_8
    s_setprio 0
    s_branch L_pb_6
L_pa_7:
    s_setprio 2
    s_mov_b32 s32, 8
    s_branch L_pb_6
L_pa_8:
    s_setprio 1
    s_mov_b32 s32, 12
    s_branch L_pb_6
L_rq_9:
    buffer_load_dwordx4 v236, s[4:7], s28 offen nt lds
    buffer_load_dwordx4 v236, s[4:7], s28 offen offset:1024 nt lds
    buffer_load_dwordx4 v236, s[4:7], s28 offen offset:2048 nt lds
    buffer_load_dwordx4 v236, s[4:7], s28 offen offset:3072 nt lds
    s_branch L_rb_10
L_vq_11:
    s_add_u32 s33, s28, 16384
    buffer_load_dwordx4 v236, s[4:7], s33 offen nt lds
    buffer_load_dwordx4 v236, s[4:7], s33 offen offset:1024 nt lds
    buffer_load_dwordx4 v236, s[4:7], s33 offen offset:2048 nt lds
    buffer_load_dwordx4 v236, s[4:7], s33 offen offset:3072 nt lds
    s_add_u32 m0, s21, 65536
    s_add_u32 s33, s28, 32768
    buffer_load_dwordx4 v236, s[4:7], s33 offen nt lds
    buffer_load_dwordx4 v236, s[4:7], s33 offen offset:1024 nt lds
    buffer_load_dwordx4 v236, s[4:7], s33 offen offset:2048 nt lds
    buffer_load_dwordx4 v236, s[4:7], s33 offen offset:3072 nt lds
    s_branch L_vb_12
L_pp_13:
    s_cmp_eq_u32 s31, 4
    s_cbranch_scc1 L_pa_15
    s_cmp_eq_u32 s31, 8
    s_cbranch_scc1 L_pa_16
    s_setprio 0
    s_branch L_pb_14
L_pa_15:
    s_setprio 2
    s_mov_b32 s32, 8
    s_branch L_pb_14
L_pa_16:
    s_setprio 1
    s_mov_b32 s32, 12
    s_branch L_pb_14
L_pp_17:
    s_cmp_eq_u32 s31, 4
    s_cbranch_scc1 L_pa_19
    s_cmp_eq_u32 s31, 8
    s_cbranch_scc1 L_pa_20
    s_setprio 0
    s_branch L_pb_18
L_pa_19:
    s_setprio 2
    s_mov_b32 s32, 8
    s_branch L_pb_18
L_pa_20:
    s_setprio 1
    s_mov_b32 s32, 12
    s_branch L_pb_18
L_pp_21:
    s_cmp_eq_u32 s31, 4
    s_cbranch_scc1 L_pa_23
    s_cmp_eq_u32 s31, 8
    s_cbranch_scc1 L_pa_24
    s_setprio 0
    s_branch L_pb_22
L_pa_23:
    s_setprio 2
    s_mov_b32 s32, 8
    s_branch L_pb_22
L_pa_24:
    s_setprio 1
    s_mov_b32 s32, 12
    s_branch L_pb_22
L_fin:
L_end:
    s_endpgm
.section .rodata,"a"
.p2align 6
.amdhsa_kernel standalone__gqa_softmax__near_ridge_kernel
  .amdhsa_next_free_vgpr 256
  .amdhsa_next_free_sgpr 48
  .amdhsa_accum_offset 256
  .amdhsa_group_segment_fixed_size 0
  .amdhsa_kernarg_size 48
  .amdhsa_user_sgpr_count 2
  .amdhsa_user_sgpr_kernarg_segment_ptr 1
  .amdhsa_system_sgpr_workgroup_id_x 1
.end_amdhsa_kernel
```
